```python
import torch

def _softmax(x, axis=-1):
    return torch.softmax(x, dim=axis)
def _gelu(x):
    return torch.nn.functional.gelu(x, approximate="tanh")
def _silu(x):
    return torch.nn.functional.silu(x)
def _sigmoid(x):
    return torch.sigmoid(x)
def _layernorm(x, axis=-1, eps=1e-5):
    m = x.mean(dim=axis, keepdim=True)
    v = x.var(dim=axis, keepdim=True, unbiased=False)
    return (x - m) / torch.sqrt(v + eps)
def _scatter_add(tgt, idx, src, axis=0):
    return tgt.clone().index_add_(axis, idx, src)
def _segment_sum(src, seg, n):
    out = torch.zeros((n,) + src.shape[1:], dtype=src.dtype)
    return out.index_add_(0, seg, src)
def _pad(x, pw):
    flat = tuple(v for pair in reversed(pw) for v in pair)
    return torch.nn.functional.pad(x, flat)

kernel_name = 'concat_heads__mha_block_cached__mha_block_cached__near_ridge'

def setup_inputs():

    _w = (lambda a: (lambda t: t.to(torch.bfloat16) if t.is_floating_point() else t)(torch.as_tensor(a)))
    def _A_setup():
        B, Sq, D = 16, 64, 448
        H, Sk, Dh = 16, 64, 256
        return {
            "x": _w((lambda *s: torch.randn(*s, dtype=torch.bfloat16) * 0.8)(B, Sq, D)),
            "k_cache": _w((lambda *s: torch.randn(*s, dtype=torch.bfloat16) * 0.8)(B, H, Sk, Dh)),
            "v_cache": _w((lambda *s: torch.randn(*s, dtype=torch.bfloat16) * 0.05)(B, H, Sk, Dh)),
            "wq": _w((lambda *s: torch.randn(*s, dtype=torch.bfloat16) * 0.8)(D, H * Dh) * (D ** -0.5)),
            "wo": _w((lambda *s: torch.randn(*s, dtype=torch.bfloat16) * 0.05)(H * Dh, D) * ((H * Dh) ** -0.5)),
        }
    _A_in = _A_setup()

    def _B_setup():
        B, Sq, D = 16, 64, 448
        H, Sk, Dh = 16, 64, 256
        return {
            "x": _w((lambda *s: torch.randn(*s, dtype=torch.bfloat16) * 0.8)(B, Sq, D)),
            "k_cache": _w((lambda *s: torch.randn(*s, dtype=torch.bfloat16) * 0.8)(B, H, Sk, Dh)),
            "v_cache": _w((lambda *s: torch.randn(*s, dtype=torch.bfloat16) * 0.05)(B, H, Sk, Dh)),
            "wq": _w((lambda *s: torch.randn(*s, dtype=torch.bfloat16) * 0.8)(D, H * Dh) * (D ** -0.5)),
            "wo": _w((lambda *s: torch.randn(*s, dtype=torch.bfloat16) * 0.05)(H * Dh, D) * ((H * Dh) ** -0.5)),
        }
    _B_in = _B_setup()

    return {
        "A_x": _A_in["x"],
        "A_k_cache": _A_in["k_cache"],
        "A_v_cache": _A_in["v_cache"],
        "A_wq": _A_in["wq"],
        "A_wo": _A_in["wo"],
        "B_x": _B_in["x"],
        "B_k_cache": _B_in["k_cache"],
        "B_v_cache": _B_in["v_cache"],
        "B_wq": _B_in["wq"],
        "B_wo": _B_in["wo"],
    }

def reference(A_x, A_k_cache, A_v_cache, A_wq, A_wo, B_x, B_k_cache, B_v_cache, B_wq, B_wo):
    def _A_ref(x, k_cache, v_cache, wq, wo):
        B, Sq, D = x.shape
        H, Dh = 16, 256
        q = (lambda x, *d: x.permute(*d))((x @ wq).reshape(B, Sq, H, Dh), 0, 2, 1, 3)
        scores = torch.einsum("bhqd,bhkd->bhqk", q, k_cache) * (Dh ** -0.5)
        p = _softmax(scores, axis=-1)
        o = torch.einsum("bhqk,bhkd->bhqd", p, v_cache)
        return (lambda x, *d: x.permute(*d))(o, 0, 2, 1, 3).reshape(B, Sq, H * Dh) @ wo

    def _B_ref(x, k_cache, v_cache, wq, wo):
        B, Sq, D = x.shape
        H, Dh = 16, 256
        q = (lambda x, *d: x.permute(*d))((x @ wq).reshape(B, Sq, H, Dh), 0, 2, 1, 3)
        scores = torch.einsum("bhqd,bhkd->bhqk", q, k_cache) * (Dh ** -0.5)
        p = _softmax(scores, axis=-1)
        o = torch.einsum("bhqk,bhkd->bhqd", p, v_cache)
        return (lambda x, *d: x.permute(*d))(o, 0, 2, 1, 3).reshape(B, Sq, H * Dh) @ wo

    a = _A_ref(A_x, A_k_cache, A_v_cache, A_wq, A_wo)
    b = _B_ref(B_x, B_k_cache, B_v_cache, B_wq, B_wo)
    return torch.concatenate([a, b], axis=-1)
```

```asm
; @launch grid=(256,1,1) block=(512,1,1) lds=163840
.amdgcn_target "amdgcn-amd-amdhsa--gfx950"
.text
.globl concat_heads__mha_block_cached__mha_block_cached__near_ridge_kernel
.p2align 8
.type concat_heads__mha_block_cached__mha_block_cached__near_ridge_kernel,@function
concat_heads__mha_block_cached__mha_block_cached__near_ridge_kernel:
    s_cmp_ge_u32 s2, 256
    s_cbranch_scc1 L_end
    s_load_dwordx16 s[4:19], s[0:1], 0
    s_load_dwordx8 s[20:27], s[0:1], 64
    s_load_dwordx2 s[28:29], s[0:1], 96
    v_lshrrev_b32 v1, 6, v0
    v_and_b32 v0, 63, v0
    s_nop 0
    v_readfirstlane_b32 s3, v1
    s_and_b32 s68, s2, 7
    s_lshr_b32 s69, s2, 3
    s_lshr_b32 s64, s68, 2
    s_and_b32 s67, s69, 1
    s_lshr_b32 s65, s69, 1
    s_and_b32 s68, s68, 3
    s_lshl_b32 s68, s68, 1
    s_add_u32 s66, s68, s67
    s_waitcnt lgkmcnt(0)
    s_cmp_eq_u32 s64, 0
    s_cselect_b64 s[4:5], s[4:5], s[14:15]
    s_cselect_b64 s[6:7], s[6:7], s[16:17]
    s_cselect_b64 s[8:9], s[8:9], s[18:19]
    s_cselect_b64 s[10:11], s[10:11], s[20:21]
    s_cselect_b64 s[12:13], s[12:13], s[22:23]
    s_mul_i32 s68, s65, 57344
    s_add_u32 s32, s4, s68
    s_addc_u32 s33, s5, 0
    s_and_b32 s33, s33, 0xffff
    s_mov_b32 s34, 57344
    s_mov_b32 s35, 0x20000
    s_lshl_b32 s68, s66, 10
    s_sub_u32 s69, 3670016, s68
    s_add_u32 s44, s10, s68
    s_addc_u32 s45, s11, 0
    s_and_b32 s45, s45, 0xffff
    s_mov_b32 s46, s69
    s_mov_b32 s47, 0x20000
    s_cmp_lt_u32 s3, 4
    s_cbranch_scc1 L_compute
L_loader:
    s_sub_u32 s76, s3, 4
    v_xor_b32 v1, 0, v0
    v_lshlrev_b32 v1, 4, v1
    v_add_u32 v8, 0, v1
    v_xor_b32 v1, 4, v0
    v_lshlrev_b32 v1, 4, v1
    v_add_u32 v9, 7168, v1
    v_xor_b32 v1, 8, v0
    v_lshlrev_b32 v1, 4, v1
    v_add_u32 v10, 14336, v1
    v_xor_b32 v1, 12, v0
    v_lshlrev_b32 v1, 4, v1
    v_add_u32 v11, 21504, v1
    v_lshrrev_b32 v2, 3, v0
    v_mul_u32_u24 v2, 896, v2
    v_and_b32 v3, 7, v0
    v_lshrrev_b32 v4, 4, v0
    v_add_u32 v5, 0, v4
    v_xor_b32 v5, v5, v3
    v_lshl_add_u32 v5, v5, 4, v2
    v_add_u32 v12, 0, v5
    v_add_u32 v5, 4, v4
    v_xor_b32 v5, v5, v3
    v_lshl_add_u32 v5, v5, 4, v2
    v_add_u32 v13, 6144, v5
    s_lshl_b32 s4, s76, 15
    s_lshl_b32 s30, s76, 12
    s_mul_i32 s5, s76, 14336
    s_lshl_b32 s31, s76, 11
    s_add_u32 s31, s31, 81920
    s_add_u32 m0, s31, 0
    s_add_u32 s74, s5, 0
    buffer_load_dwordx4 v12, s[32:35], s74 offen lds
    buffer_load_dwordx4 v13, s[32:35], s74 offen offset:1024 lds
    s_add_u32 m0, s30, 0
    s_add_u32 s74, s4, 0
    buffer_load_dwordx4 v8, s[44:47], s74 offen lds
    buffer_load_dwordx4 v9, s[44:47], s74 offen offset:1024 lds
    buffer_load_dwordx4 v10, s[44:47], s74 offen offset:2048 lds
    buffer_load_dwordx4 v11, s[44:47], s74 offen offset:3072 lds
    s_add_u32 m0, s30, 16384
    s_add_u32 s74, s4, 131072
    buffer_load_dwordx4 v8, s[44:47], s74 offen lds
    buffer_load_dwordx4 v9, s[44:47], s74 offen offset:1024 lds
    buffer_load_dwordx4 v10, s[44:47], s74 offen offset:2048 lds
    buffer_load_dwordx4 v11, s[44:47], s74 offen offset:3072 lds
    s_add_u32 m0, s30, 32768
    s_add_u32 s74, s4, 262144
    buffer_load_dwordx4 v8, s[44:47], s74 offen lds
    buffer_load_dwordx4 v9, s[44:47], s74 offen offset:1024 lds
    buffer_load_dwordx4 v10, s[44:47], s74 offen offset:2048 lds
    buffer_load_dwordx4 v11, s[44:47], s74 offen offset:3072 lds
    s_add_u32 m0, s30, 49152
    s_add_u32 s74, s4, 393216
    buffer_load_dwordx4 v8, s[44:47], s74 offen lds
    buffer_load_dwordx4 v9, s[44:47], s74 offen offset:1024 lds
    buffer_load_dwordx4 v10, s[44:47], s74 offen offset:2048 lds
    buffer_load_dwordx4 v11, s[44:47], s74 offen offset:3072 lds
    s_lshl_b32 s68, s65, 19
    s_lshl_b32 s69, s66, 16
    s_add_u32 s68, s68, s69
    s_add_u32 s36, s6, s68
    s_addc_u32 s37, s7, 0
    s_and_b32 s37, s37, 0xffff
    s_mov_b32 s38, 65536
    s_mov_b32 s39, 0x20000
    s_add_u32 s40, s8, s68
    s_addc_u32 s41, s9, 0
    s_and_b32 s41, s41, 0xffff
    s_mov_b32 s42, 65536
    s_mov_b32 s43, 0x20000
    s_mul_i32 s68, s66, 458752
    s_add_u32 s48, s12, s68
    s_addc_u32 s49, s13, 0
    s_and_b32 s49, s49, 0xffff
    s_mov_b32 s50, 458752
    s_mov_b32 s51, 0x20000
    s_lshl_b32 s68, s64, 4
    s_add_u32 s68, s68, s65
    s_lshl_b32 s68, s68, 3
    s_add_u32 s68, s68, s66
    s_mul_i32 s68, s68, 57344
    s_add_u32 s52, s28, s68
    s_addc_u32 s53, s29, 0
    s_and_b32 s53, s53, 0xffff
    s_mov_b32 s54, 57344
    s_mov_b32 s55, 0x20000
    s_lshl_b32 s68, s64, 4
    s_add_u32 s68, s68, s65
    s_lshl_b32 s68, s68, 3
    s_add_u32 s56, s26, s68
    s_addc_u32 s57, s27, 0
    s_and_b32 s57, s57, 0xffff
    s_mov_b32 s58, 4
    s_mov_b32 s59, 0x20000
    s_lshl_b32 s68, s68, 8
    s_add_u32 s68, s68, 0x4000000
    s_add_u32 s16, s28, s68
    s_addc_u32 s17, s29, 0
    s_and_b32 s17, s17, 0xffff
    s_mov_b32 s18, 2048
    s_mov_b32 s19, 0x20000
    v_lshrrev_b32 v1, 5, v0
    v_and_b32 v2, 31, v0
    v_xor_b32 v3, v2, v1
    v_lshlrev_b32 v3, 4, v3
    v_lshl_add_u32 v3, v1, 9, v3
    v_xor_b32 v20, 0, v3
    v_xor_b32 v21, 32, v3
    v_xor_b32 v22, 64, v3
    v_xor_b32 v23, 96, v3
    v_xor_b32 v24, 128, v3
    v_xor_b32 v25, 160, v3
    v_xor_b32 v26, 192, v3
    v_xor_b32 v27, 224, v3
    s_lshl_b32 s77, s76, 14
    v_lshlrev_b32 v28, 4, v0
    s_add_u32 m0, s31, 8192
    s_add_u32 s74, s5, 128
    buffer_load_dwordx4 v12, s[32:35], s74 offen lds
    buffer_load_dwordx4 v13, s[32:35], s74 offen offset:1024 lds
    v_lshrrev_b32 v1, 3, v0
    v_and_b32 v2, 7, v0
    v_lshlrev_b32 v2, 7, v2
    v_lshl_add_u32 v32, v1, 17, v2
    s_lshl_b32 s68, s76, 20
    s_lshl_b32 s69, s65, 13
    s_add_u32 s68, s68, s69
    s_mov_b32 s7, s68
    s_lshl_b32 s68, 1, s76
    s_and_b32 s68, s68, 3
    s_cselect_b64 exec, -1, 0
    buffer_load_dword v36, v32, s[44:47], s7 offen
    s_mov_b64 exec, -1
    v_and_b32 v1, 31, v0
    v_mul_u32_u24 v1, 896, v1
    v_lshrrev_b32 v2, 5, v0
    v_lshl_add_u32 v33, v2, 7, v1
    s_mul_i32 s68, s67, 28672
    s_lshl_b32 s69, s76, 8
    s_add_u32 s68, s68, s69
    v_lshrrev_b32 v1, 3, v0
    v_mul_u32_u24 v1, 896, v1
    v_and_b32 v2, 7, v0
    v_bfe_u32 v3, v0, 4, 1
    v_lshlrev_b32 v3, 2, v3
    v_xor_b32 v2, v2, v3
    v_lshl_add_u32 v1, v2, 4, v1
    v_add_u32 v16, 0, v1
    v_add_u32 v17, 6144, v1
    v_add_u32 v18, 12288, v1
    v_add_u32 v19, 18432, v1
    s_mul_i32 s62, s76, 28672
    v_lshrrev_b32 v1, 5, v0
    v_and_b32 v2, 31, v0
    v_or_b32 v4, 0, v1
    v_lshlrev_b32 v4, 2, v4
    v_xor_b32 v4, v4, v2
    v_lshlrev_b32 v4, 4, v4
    v_lshl_add_u32 v4, v1, 9, v4
    v_add_u32 v29, s77, v4
    v_or_b32 v4, 2, v1
    v_lshlrev_b32 v4, 2, v4
    v_xor_b32 v4, v4, v2
    v_lshlrev_b32 v4, 4, v4
    v_lshl_add_u32 v4, v1, 9, v4
    v_add_u32 v30, s77, v4
    s_waitcnt vmcnt(15)
    s_barrier
    s_add_u32 m0, s30, 65536
    s_add_u32 s74, s4, 524288
    buffer_load_dwordx4 v8, s[44:47], s74 offen lds
    buffer_load_dwordx4 v9, s[44:47], s74 offen offset:1024 lds
    buffer_load_dwordx4 v10, s[44:47], s74 offen offset:2048 lds
    buffer_load_dwordx4 v11, s[44:47], s74 offen offset:3072 lds
    s_add_u32 s74, s77, 0
    s_add_u32 m0, s74, 98304
    s_nop 0
    buffer_load_dwordx4 v20, s[36:39], s74 offen nt lds
    s_add_u32 s74, s77, 1024
    s_add_u32 m0, s74, 98304
    s_nop 0
    buffer_load_dwordx4 v21, s[36:39], s74 offen nt lds
    s_add_u32 s74, s77, 2048
    s_add_u32 m0, s74, 98304
    s_nop 0
    buffer_load_dwordx4 v22, s[36:39], s74 offen nt lds
    s_add_u32 s74, s77, 3072
    s_add_u32 m0, s74, 98304
    s_nop 0
    buffer_load_dwordx4 v23, s[36:39], s74 offen nt lds
    s_waitcnt vmcnt(19)
    s_barrier
    s_add_u32 m0, s30, 0
    s_add_u32 s74, s4, 655360
    buffer_load_dwordx4 v8, s[44:47], s74 offen lds
    buffer_load_dwordx4 v9, s[44:47], s74 offen offset:1024 lds
    buffer_load_dwordx4 v10, s[44:47], s74 offen offset:2048 lds
    buffer_load_dwordx4 v11, s[44:47], s74 offen offset:3072 lds
    s_waitcnt vmcnt(19)
    s_barrier
    s_add_u32 m0, s30, 16384
    s_add_u32 s74, s4, 786432
    buffer_load_dwordx4 v8, s[44:47], s74 offen lds
    buffer_load_dwordx4 v9, s[44:47], s74 offen offset:1024 lds
    buffer_load_dwordx4 v10, s[44:47], s74 offen offset:2048 lds
    buffer_load_dwordx4 v11, s[44:47], s74 offen offset:3072 lds
    s_waitcnt vmcnt(19)
    s_barrier
    s_add_u32 m0, s30, 32768
    s_add_u32 s74, s4, 917504
    buffer_load_dwordx4 v8, s[44:47], s74 offen lds
    buffer_load_dwordx4 v9, s[44:47], s74 offen offset:1024 lds
    buffer_load_dwordx4 v10, s[44:47], s74 offen offset:2048 lds
    buffer_load_dwordx4 v11, s[44:47], s74 offen offset:3072 lds
    s_waitcnt vmcnt(16)
    s_barrier
    s_add_u32 m0, s30, 49152
    s_add_u32 s74, s4, 1048576
    buffer_load_dwordx4 v8, s[44:47], s74 offen lds
    buffer_load_dwordx4 v9, s[44:47], s74 offen offset:1024 lds
    buffer_load_dwordx4 v10, s[44:47], s74 offen offset:2048 lds
    buffer_load_dwordx4 v11, s[44:47], s74 offen offset:3072 lds
    s_add_u32 m0, s31, 0
    s_add_u32 s74, s5, 256
    buffer_load_dwordx4 v12, s[32:35], s74 offen lds
    buffer_load_dwordx4 v13, s[32:35], s74 offen offset:1024 lds
    s_lshl_b32 s68, 1, s76
    s_and_b32 s68, s68, 4
    s_cselect_b64 exec, -1, 0
    buffer_load_dword v36, v32, s[44:47], s7 offen
    s_mov_b64 exec, -1
    s_add_u32 s74, s77, 4096
    s_add_u32 m0, s74, 98304
    s_nop 0
    buffer_load_dwordx4 v24, s[36:39], s74 offen nt lds
    s_add_u32 s74, s77, 5120
    s_add_u32 m0, s74, 98304
    s_nop 0
    buffer_load_dwordx4 v25, s[36:39], s74 offen nt lds
    s_add_u32 s74, s77, 6144
    s_add_u32 m0, s74, 98304
    s_nop 0
    buffer_load_dwordx4 v26, s[36:39], s74 offen nt lds
    s_add_u32 s74, s77, 7168
    s_add_u32 m0, s74, 98304
    s_nop 0
    buffer_load_dwordx4 v27, s[36:39], s74 offen nt lds
    s_waitcnt vmcnt(19)
    s_barrier
    s_add_u32 m0, s30, 65536
    s_add_u32 s74, s4, 1179648
    buffer_load_dwordx4 v8, s[44:47], s74 offen lds
    buffer_load_dwordx4 v9, s[44:47], s74 offen offset:1024 lds
    buffer_load_dwordx4 v10, s[44:47], s74 offen offset:2048 lds
    buffer_load_dwordx4 v11, s[44:47], s74 offen offset:3072 lds
    s_waitcnt vmcnt(19)
    s_barrier
    s_add_u32 m0, s30, 0
    s_add_u32 s74, s4, 1310720
    buffer_load_dwordx4 v8, s[44:47], s74 offen lds
    buffer_load_dwordx4 v9, s[44:47], s74 offen offset:1024 lds
    buffer_load_dwordx4 v10, s[44:47], s74 offen offset:2048 lds
    buffer_load_dwordx4 v11, s[44:47], s74 offen offset:3072 lds
    s_waitcnt vmcnt(19)
    s_barrier
    s_add_u32 m0, s30, 16384
    s_add_u32 s74, s4, 1441792
    buffer_load_dwordx4 v8, s[44:47], s74 offen lds
    buffer_load_dwordx4 v9, s[44:47], s74 offen offset:1024 lds
    buffer_load_dwordx4 v10, s[44:47], s74 offen offset:2048 lds
    buffer_load_dwordx4 v11, s[44:47], s74 offen offset:3072 lds
    s_waitcnt vmcnt(17)
    s_barrier
    s_add_u32 m0, s30, 32768
    s_add_u32 s74, s4, 1572864
    buffer_load_dwordx4 v8, s[44:47], s74 offen lds
    buffer_load_dwordx4 v9, s[44:47], s74 offen offset:1024 lds
    buffer_load_dwordx4 v10, s[44:47], s74 offen offset:2048 lds
    buffer_load_dwordx4 v11, s[44:47], s74 offen offset:3072 lds
    s_add_u32 m0, s31, 8192
    s_add_u32 s74, s5, 384
    buffer_load_dwordx4 v12, s[32:35], s74 offen lds
    buffer_load_dwordx4 v13, s[32:35], s74 offen offset:1024 lds
    s_add_u32 s74, s77, 8192
    s_add_u32 m0, s74, 98304
    s_nop 0
    buffer_load_dwordx4 v20, s[36:39], s74 offen nt lds
    s_add_u32 s74, s77, 9216
    s_add_u32 m0, s74, 98304
    s_nop 0
    buffer_load_dwordx4 v21, s[36:39], s74 offen nt lds
    s_add_u32 s74, s77, 10240
    s_add_u32 m0, s74, 98304
    s_nop 0
    buffer_load_dwordx4 v22, s[36:39], s74 offen nt lds
    s_add_u32 s74, s77, 11264
    s_add_u32 m0, s74, 98304
    s_nop 0
    buffer_load_dwordx4 v23, s[36:39], s74 offen nt lds
    s_waitcnt vmcnt(18)
    s_barrier
    s_add_u32 m0, s30, 49152
    s_add_u32 s74, s4, 1703936
    buffer_load_dwordx4 v8, s[44:47], s74 offen lds
    buffer_load_dwordx4 v9, s[44:47], s74 offen offset:1024 lds
    buffer_load_dwordx4 v10, s[44:47], s74 offen offset:2048 lds
    buffer_load_dwordx4 v11, s[44:47], s74 offen offset:3072 lds
    s_waitcnt vmcnt(18)
    s_barrier
    s_add_u32 m0, s30, 65536
    s_add_u32 s74, s4, 1835008
    buffer_load_dwordx4 v8, s[44:47], s74 offen lds
    buffer_load_dwordx4 v9, s[44:47], s74 offen offset:1024 lds
    buffer_load_dwordx4 v10, s[44:47], s74 offen offset:2048 lds
    buffer_load_dwordx4 v11, s[44:47], s74 offen offset:3072 lds
    s_waitcnt vmcnt(18)
    s_barrier
    s_add_u32 m0, s30, 0
    s_add_u32 s74, s4, 1966080
    buffer_load_dwordx4 v8, s[44:47], s74 offen lds
    buffer_load_dwordx4 v9, s[44:47], s74 offen offset:1024 lds
    buffer_load_dwordx4 v10, s[44:47], s74 offen offset:2048 lds
    buffer_load_dwordx4 v11, s[44:47], s74 offen offset:3072 lds
    s_waitcnt vmcnt(16)
    s_barrier
    s_add_u32 m0, s30, 16384
    s_add_u32 s74, s4, 2097152
    buffer_load_dwordx4 v8, s[44:47], s74 offen lds
    buffer_load_dwordx4 v9, s[44:47], s74 offen offset:1024 lds
    buffer_load_dwordx4 v10, s[44:47], s74 offen offset:2048 lds
    buffer_load_dwordx4 v11, s[44:47], s74 offen offset:3072 lds
    s_add_u32 m0, s31, 0
    s_add_u32 s74, s5, 512
    buffer_load_dwordx4 v12, s[32:35], s74 offen lds
    buffer_load_dwordx4 v13, s[32:35], s74 offen offset:1024 lds
    s_lshl_b32 s68, 1, s76
    s_and_b32 s68, s68, 8
    s_cselect_b64 exec, -1, 0
    buffer_load_dword v36, v32, s[44:47], s7 offen
    s_mov_b64 exec, -1
    s_add_u32 s74, s77, 12288
    s_add_u32 m0, s74, 98304
    s_nop 0
    buffer_load_dwordx4 v24, s[36:39], s74 offen nt lds
    s_add_u32 s74, s77, 13312
    s_add_u32 m0, s74, 98304
    s_nop 0
    buffer_load_dwordx4 v25, s[36:39], s74 offen nt lds
    s_add_u32 s74, s77, 14336
    s_add_u32 m0, s74, 98304
    s_nop 0
    buffer_load_dwordx4 v26, s[36:39], s74 offen nt lds
    s_add_u32 s74, s77, 15360
    s_add_u32 m0, s74, 98304
    s_nop 0
    buffer_load_dwordx4 v27, s[36:39], s74 offen nt lds
    s_waitcnt vmcnt(19)
    s_barrier
    s_add_u32 m0, s30, 32768
    s_add_u32 s74, s4, 2228224
    buffer_load_dwordx4 v8, s[44:47], s74 offen lds
    buffer_load_dwordx4 v9, s[44:47], s74 offen offset:1024 lds
    buffer_load_dwordx4 v10, s[44:47], s74 offen offset:2048 lds
    buffer_load_dwordx4 v11, s[44:47], s74 offen offset:3072 lds
    s_waitcnt vmcnt(19)
    s_barrier
    s_add_u32 m0, s30, 49152
    s_add_u32 s74, s4, 2359296
    buffer_load_dwordx4 v8, s[44:47], s74 offen lds
    buffer_load_dwordx4 v9, s[44:47], s74 offen offset:1024 lds
    buffer_load_dwordx4 v10, s[44:47], s74 offen offset:2048 lds
    buffer_load_dwordx4 v11, s[44:47], s74 offen offset:3072 lds
    s_waitcnt vmcnt(19)
    s_barrier
    s_add_u32 m0, s30, 65536
    s_add_u32 s74, s4, 2490368
    buffer_load_dwordx4 v8, s[44:47], s74 offen lds
    buffer_load_dwordx4 v9, s[44:47], s74 offen offset:1024 lds
    buffer_load_dwordx4 v10, s[44:47], s74 offen offset:2048 lds
    buffer_load_dwordx4 v11, s[44:47], s74 offen offset:3072 lds
    s_waitcnt vmcnt(17)
    s_barrier
    s_add_u32 m0, s30, 0
    s_add_u32 s74, s4, 2621440
    buffer_load_dwordx4 v8, s[44:47], s74 offen lds
    buffer_load_dwordx4 v9, s[44:47], s74 offen offset:1024 lds
    buffer_load_dwordx4 v10, s[44:47], s74 offen offset:2048 lds
    buffer_load_dwordx4 v11, s[44:47], s74 offen offset:3072 lds
    s_add_u32 m0, s31, 8192
    s_add_u32 s74, s5, 640
    buffer_load_dwordx4 v12, s[32:35], s74 offen lds
    buffer_load_dwordx4 v13, s[32:35], s74 offen offset:1024 lds
    s_add_u32 s74, s77, 0
    buffer_load_dwordx4 v[64:67], v28, s[40:43], s74 offen offset:0 nt
    s_add_u32 s74, s77, 0
    buffer_load_dwordx4 v[68:71], v28, s[40:43], s74 offen offset:1024 nt
    s_add_u32 s74, s77, 0
    buffer_load_dwordx4 v[72:75], v28, s[40:43], s74 offen offset:2048 nt
    s_add_u32 s74, s77, 0
    buffer_load_dwordx4 v[76:79], v28, s[40:43], s74 offen offset:3072 nt
    s_waitcnt vmcnt(18)
    s_barrier
    s_add_u32 m0, s30, 16384
    s_add_u32 s74, s4, 2752512
    buffer_load_dwordx4 v8, s[44:47], s74 offen lds
    buffer_load_dwordx4 v9, s[44:47], s74 offen offset:1024 lds
    buffer_load_dwordx4 v10, s[44:47], s74 offen offset:2048 lds
    buffer_load_dwordx4 v11, s[44:47], s74 offen offset:3072 lds
    s_waitcnt vmcnt(18)
    s_barrier
    s_add_u32 m0, s30, 32768
    s_add_u32 s74, s4, 2883584
    buffer_load_dwordx4 v8, s[44:47], s74 offen lds
    buffer_load_dwordx4 v9, s[44:47], s74 offen offset:1024 lds
    buffer_load_dwordx4 v10, s[44:47], s74 offen offset:2048 lds
    buffer_load_dwordx4 v11, s[44:47], s74 offen offset:3072 lds
    s_waitcnt vmcnt(18)
    s_barrier
    s_add_u32 m0, s30, 49152
    s_add_u32 s74, s4, 3014656
    buffer_load_dwordx4 v8, s[44:47], s74 offen lds
    buffer_load_dwordx4 v9, s[44:47], s74 offen offset:1024 lds
    buffer_load_dwordx4 v10, s[44:47], s74 offen offset:2048 lds
    buffer_load_dwordx4 v11, s[44:47], s74 offen offset:3072 lds
    s_waitcnt vmcnt(16)
    s_barrier
    s_add_u32 m0, s30, 65536
    s_add_u32 s74, s4, 3145728
    buffer_load_dwordx4 v8, s[44:47], s74 offen lds
    buffer_load_dwordx4 v9, s[44:47], s74 offen offset:1024 lds
    buffer_load_dwordx4 v10, s[44:47], s74 offen offset:2048 lds
    buffer_load_dwordx4 v11, s[44:47], s74 offen offset:3072 lds
    s_add_u32 m0, s31, 0
    s_add_u32 s74, s5, 768
    buffer_load_dwordx4 v12, s[32:35], s74 offen lds
    buffer_load_dwordx4 v13, s[32:35], s74 offen offset:1024 lds
    s_add_u32 s74, s77, 4096
    buffer_load_dwordx4 v[80:83], v28, s[40:43], s74 offen offset:0 nt
    s_add_u32 s74, s77, 4096
    buffer_load_dwordx4 v[84:87], v28, s[40:43], s74 offen offset:1024 nt
    s_add_u32 s74, s77, 4096
    buffer_load_dwordx4 v[88:91], v28, s[40:43], s74 offen offset:2048 nt
    s_add_u32 s74, s77, 4096
    buffer_load_dwordx4 v[92:95], v28, s[40:43], s74 offen offset:3072 nt
    s_waitcnt vmcnt(18)
    s_barrier
    s_add_u32 m0, s30, 0
    s_add_u32 s74, s4, 3276800
    buffer_load_dwordx4 v8, s[44:47], s74 offen lds
    buffer_load_dwordx4 v9, s[44:47], s74 offen offset:1024 lds
    buffer_load_dwordx4 v10, s[44:47], s74 offen offset:2048 lds
    buffer_load_dwordx4 v11, s[44:47], s74 offen offset:3072 lds
    s_waitcnt vmcnt(18)
    s_barrier
    s_add_u32 m0, s30, 16384
    s_add_u32 s74, s4, 3407872
    buffer_load_dwordx4 v8, s[44:47], s74 offen lds
    buffer_load_dwordx4 v9, s[44:47], s74 offen offset:1024 lds
    buffer_load_dwordx4 v10, s[44:47], s74 offen offset:2048 lds
    buffer_load_dwordx4 v11, s[44:47], s74 offen offset:3072 lds
    s_waitcnt vmcnt(18)
    s_barrier
    s_add_u32 m0, s30, 32768
    s_add_u32 s74, s4, 3538944
    buffer_load_dwordx4 v8, s[44:47], s74 offen lds
    buffer_load_dwordx4 v9, s[44:47], s74 offen offset:1024 lds
    buffer_load_dwordx4 v10, s[44:47], s74 offen offset:2048 lds
    buffer_load_dwordx4 v11, s[44:47], s74 offen offset:3072 lds
    s_waitcnt vmcnt(16)
    s_barrier
    s_add_u32 s74, s77, 8192
    buffer_load_dwordx4 v[96:99], v28, s[40:43], s74 offen offset:0 nt
    s_add_u32 s74, s77, 8192
    buffer_load_dwordx4 v[100:103], v28, s[40:43], s74 offen offset:1024 nt
    s_add_u32 s74, s77, 8192
    buffer_load_dwordx4 v[104:107], v28, s[40:43], s74 offen offset:2048 nt
    s_add_u32 s74, s77, 8192
    buffer_load_dwordx4 v[108:111], v28, s[40:43], s74 offen offset:3072 nt
    s_waitcnt vmcnt(12)
    s_barrier
    s_waitcnt vmcnt(8)
    s_barrier
    s_waitcnt vmcnt(4)
    s_barrier
    s_barrier
    s_add_u32 s74, s77, 12288
    buffer_load_dwordx4 v[112:115], v28, s[40:43], s74 offen offset:0 nt
    s_add_u32 s74, s77, 12288
    buffer_load_dwordx4 v[116:119], v28, s[40:43], s74 offen offset:1024 nt
    s_add_u32 s74, s77, 12288
    buffer_load_dwordx4 v[120:123], v28, s[40:43], s74 offen offset:2048 nt
    s_add_u32 s74, s77, 12288
    buffer_load_dwordx4 v[124:127], v28, s[40:43], s74 offen offset:3072 nt
    s_mov_b32 exec_lo, 0x3060c183
    s_mov_b32 exec_hi, 0x60c18
    s_mul_i32 s68, s65, 28672
    s_mul_i32 s69, s76, 7168
    s_add_u32 s68, s68, s69
    v_lshlrev_b32 v6, 7, v0
    buffer_load_dword v36, v6, s[48:51], s68 offen
    s_mov_b64 exec, -1
    s_add_u32 s74, s62, 128
    buffer_load_dwordx4 v[128:131], v16, s[48:51], s74 offen
    buffer_load_dwordx4 v[132:135], v17, s[48:51], s74 offen offset:1024
    buffer_load_dwordx4 v[136:139], v18, s[48:51], s74 offen offset:2048
    buffer_load_dwordx4 v[140:143], v19, s[48:51], s74 offen offset:3072
    s_add_u32 s74, s62, 114816
    buffer_load_dwordx4 v[144:147], v16, s[48:51], s74 offen
    buffer_load_dwordx4 v[148:151], v17, s[48:51], s74 offen offset:1024
    buffer_load_dwordx4 v[152:155], v18, s[48:51], s74 offen offset:2048
    buffer_load_dwordx4 v[156:159], v19, s[48:51], s74 offen offset:3072
    ds_write_b128 v29, v[64:67] offset:0
    ds_write_b128 v30, v[68:71] offset:1024
    ds_write_b128 v29, v[72:75] offset:2048
    ds_write_b128 v30, v[76:79] offset:3072
    ds_write_b128 v29, v[80:83] offset:4096
    ds_write_b128 v30, v[84:87] offset:5120
    ds_write_b128 v29, v[88:91] offset:6144
    ds_write_b128 v30, v[92:95] offset:7168
    s_waitcnt vmcnt(13)
    ds_write_b128 v29, v[96:99] offset:8192
    ds_write_b128 v30, v[100:103] offset:9216
    ds_write_b128 v29, v[104:107] offset:10240
    ds_write_b128 v30, v[108:111] offset:11264
    s_waitcnt vmcnt(9)
    ds_write_b128 v29, v[112:115] offset:12288
    ds_write_b128 v30, v[116:119] offset:13312
    ds_write_b128 v29, v[120:123] offset:14336
    ds_write_b128 v30, v[124:127] offset:15360
    s_waitcnt lgkmcnt(0)
    s_barrier
    s_add_u32 m0, s30, 98304
    s_add_u32 s74, s62, 0
    buffer_load_dwordx4 v16, s[48:51], s74 offen lds
    buffer_load_dwordx4 v17, s[48:51], s74 offen offset:1024 lds
    buffer_load_dwordx4 v18, s[48:51], s74 offen offset:2048 lds
    buffer_load_dwordx4 v19, s[48:51], s74 offen offset:3072 lds
    s_add_u32 m0, s30, 114688
    s_add_u32 s74, s62, 114688
    buffer_load_dwordx4 v16, s[48:51], s74 offen lds
    buffer_load_dwordx4 v17, s[48:51], s74 offen offset:1024 lds
    buffer_load_dwordx4 v18, s[48:51], s74 offen offset:2048 lds
    buffer_load_dwordx4 v19, s[48:51], s74 offen offset:3072 lds
    s_add_u32 m0, s30, 131072
    s_add_u32 s74, s62, 229376
    buffer_load_dwordx4 v16, s[48:51], s74 offen lds
    buffer_load_dwordx4 v17, s[48:51], s74 offen offset:1024 lds
    buffer_load_dwordx4 v18, s[48:51], s74 offen offset:2048 lds
    buffer_load_dwordx4 v19, s[48:51], s74 offen offset:3072 lds
    s_add_u32 m0, s30, 147456
    s_add_u32 s74, s62, 344064
    buffer_load_dwordx4 v16, s[48:51], s74 offen lds
    buffer_load_dwordx4 v17, s[48:51], s74 offen offset:1024 lds
    buffer_load_dwordx4 v18, s[48:51], s74 offen offset:2048 lds
    buffer_load_dwordx4 v19, s[48:51], s74 offen offset:3072 lds
    s_mov_b32 exec_lo, 0xcf9f3e7c
    s_mov_b32 exec_hi, 0xf9f3e7
    s_mul_i32 s68, s65, 28672
    s_mul_i32 s69, s76, 7168
    s_add_u32 s68, s68, s69
    v_lshlrev_b32 v6, 7, v0
    buffer_load_dword v36, v6, s[48:51], s68 offen
    s_mov_b64 exec, -1
    s_waitcnt vmcnt(13)
    s_barrier
    s_add_u32 s68, s30, 0
    v_add_u32 v5, s68, v28
    ds_write_b128 v5, v[128:131] offset:0
    ds_write_b128 v5, v[132:135] offset:1024
    ds_write_b128 v5, v[136:139] offset:2048
    ds_write_b128 v5, v[140:143] offset:3072
    s_add_u32 s68, s30, 16384
    v_add_u32 v5, s68, v28
    ds_write_b128 v5, v[144:147] offset:0
    ds_write_b128 v5, v[148:151] offset:1024
    ds_write_b128 v5, v[152:155] offset:2048
    ds_write_b128 v5, v[156:159] offset:3072
    s_barrier
    s_waitcnt vmcnt(9)
    s_barrier
    s_add_u32 m0, s30, 98304
    s_add_u32 s74, s62, 229504
    buffer_load_dwordx4 v16, s[48:51], s74 offen lds
    buffer_load_dwordx4 v17, s[48:51], s74 offen offset:1024 lds
    buffer_load_dwordx4 v18, s[48:51], s74 offen offset:2048 lds
    buffer_load_dwordx4 v19, s[48:51], s74 offen offset:3072 lds
    s_waitcnt vmcnt(9)
    s_barrier
    s_add_u32 m0, s30, 114688
    s_add_u32 s74, s62, 344192
    buffer_load_dwordx4 v16, s[48:51], s74 offen lds
    buffer_load_dwordx4 v17, s[48:51], s74 offen offset:1024 lds
    buffer_load_dwordx4 v18, s[48:51], s74 offen offset:2048 lds
    buffer_load_dwordx4 v19, s[48:51], s74 offen offset:3072 lds
    s_waitcnt vmcnt(9)
    s_barrier
    s_add_u32 m0, s30, 131072
    s_add_u32 s74, s62, 256
    buffer_load_dwordx4 v16, s[48:51], s74 offen lds
    buffer_load_dwordx4 v17, s[48:51], s74 offen offset:1024 lds
    buffer_load_dwordx4 v18, s[48:51], s74 offen offset:2048 lds
    buffer_load_dwordx4 v19, s[48:51], s74 offen offset:3072 lds
    s_waitcnt lgkmcnt(0)
    s_barrier
    s_add_u32 m0, s30, 147456
    s_add_u32 s74, s62, 114944
    buffer_load_dwordx4 v16, s[48:51], s74 offen lds
    buffer_load_dwordx4 v17, s[48:51], s74 offen offset:1024 lds
    buffer_load_dwordx4 v18, s[48:51], s74 offen offset:2048 lds
    buffer_load_dwordx4 v19, s[48:51], s74 offen offset:3072 lds
    s_waitcnt lgkmcnt(0)
    s_barrier
    s_add_u32 m0, s30, 0
    s_add_u32 s74, s62, 229632
    buffer_load_dwordx4 v16, s[48:51], s74 offen lds
    buffer_load_dwordx4 v17, s[48:51], s74 offen offset:1024 lds
    buffer_load_dwordx4 v18, s[48:51], s74 offen offset:2048 lds
    buffer_load_dwordx4 v19, s[48:51], s74 offen offset:3072 lds
    s_waitcnt vmcnt(16)
    s_barrier
    s_add_u32 m0, s30, 16384
    s_add_u32 s74, s62, 344320
    buffer_load_dwordx4 v16, s[48:51], s74 offen lds
    buffer_load_dwordx4 v17, s[48:51], s74 offen offset:1024 lds
    buffer_load_dwordx4 v18, s[48:51], s74 offen offset:2048 lds
    buffer_load_dwordx4 v19, s[48:51], s74 offen offset:3072 lds
    s_waitcnt vmcnt(16)
    s_barrier
    s_add_u32 m0, s30, 98304
    s_add_u32 s74, s62, 384
    buffer_load_dwordx4 v16, s[48:51], s74 offen lds
    buffer_load_dwordx4 v17, s[48:51], s74 offen offset:1024 lds
    buffer_load_dwordx4 v18, s[48:51], s74 offen offset:2048 lds
    buffer_load_dwordx4 v19, s[48:51], s74 offen offset:3072 lds
    s_waitcnt vmcnt(16)
    s_barrier
    s_add_u32 m0, s30, 114688
    s_add_u32 s74, s62, 115072
    buffer_load_dwordx4 v16, s[48:51], s74 offen lds
    buffer_load_dwordx4 v17, s[48:51], s74 offen offset:1024 lds
    buffer_load_dwordx4 v18, s[48:51], s74 offen offset:2048 lds
    buffer_load_dwordx4 v19, s[48:51], s74 offen offset:3072 lds
    s_waitcnt vmcnt(16)
    s_barrier
    s_add_u32 m0, s30, 131072
    s_add_u32 s74, s62, 229760
    buffer_load_dwordx4 v16, s[48:51], s74 offen lds
    buffer_load_dwordx4 v17, s[48:51], s74 offen offset:1024 lds
    buffer_load_dwordx4 v18, s[48:51], s74 offen offset:2048 lds
    buffer_load_dwordx4 v19, s[48:51], s74 offen offset:3072 lds
    s_waitcnt vmcnt(16)
    s_barrier
    s_add_u32 m0, s30, 147456
    s_add_u32 s74, s62, 344448
    buffer_load_dwordx4 v16, s[48:51], s74 offen lds
    buffer_load_dwordx4 v17, s[48:51], s74 offen offset:1024 lds
    buffer_load_dwordx4 v18, s[48:51], s74 offen offset:2048 lds
    buffer_load_dwordx4 v19, s[48:51], s74 offen offset:3072 lds
    s_waitcnt vmcnt(16)
    s_barrier
    s_add_u32 m0, s30, 0
    s_add_u32 s74, s62, 512
    buffer_load_dwordx4 v16, s[48:51], s74 offen lds
    buffer_load_dwordx4 v17, s[48:51], s74 offen offset:1024 lds
    buffer_load_dwordx4 v18, s[48:51], s74 offen offset:2048 lds
    buffer_load_dwordx4 v19, s[48:51], s74 offen offset:3072 lds
    s_waitcnt vmcnt(16)
    s_barrier
    s_add_u32 m0, s30, 16384
    s_add_u32 s74, s62, 115200
    buffer_load_dwordx4 v16, s[48:51], s74 offen lds
    buffer_load_dwordx4 v17, s[48:51], s74 offen offset:1024 lds
    buffer_load_dwordx4 v18, s[48:51], s74 offen offset:2048 lds
    buffer_load_dwordx4 v19, s[48:51], s74 offen offset:3072 lds
    s_waitcnt vmcnt(16)
    s_barrier
    s_add_u32 m0, s30, 98304
    s_add_u32 s74, s62, 229888
    buffer_load_dwordx4 v16, s[48:51], s74 offen lds
    buffer_load_dwordx4 v17, s[48:51], s74 offen offset:1024 lds
    buffer_load_dwordx4 v18, s[48:51], s74 offen offset:2048 lds
    buffer_load_dwordx4 v19, s[48:51], s74 offen offset:3072 lds
    s_waitcnt vmcnt(16)
    s_barrier
    s_add_u32 m0, s30, 114688
    s_add_u32 s74, s62, 344576
    buffer_load_dwordx4 v16, s[48:51], s74 offen lds
    buffer_load_dwordx4 v17, s[48:51], s74 offen offset:1024 lds
    buffer_load_dwordx4 v18, s[48:51], s74 offen offset:2048 lds
    buffer_load_dwordx4 v19, s[48:51], s74 offen offset:3072 lds
    s_waitcnt vmcnt(16)
    s_barrier
    s_add_u32 m0, s30, 131072
    s_add_u32 s74, s62, 640
    buffer_load_dwordx4 v16, s[48:51], s74 offen lds
    buffer_load_dwordx4 v17, s[48:51], s74 offen offset:1024 lds
    buffer_load_dwordx4 v18, s[48:51], s74 offen offset:2048 lds
    buffer_load_dwordx4 v19, s[48:51], s74 offen offset:3072 lds
    s_waitcnt vmcnt(16)
    s_barrier
    s_add_u32 m0, s30, 147456
    s_add_u32 s74, s62, 115328
    buffer_load_dwordx4 v16, s[48:51], s74 offen lds
    buffer_load_dwordx4 v17, s[48:51], s74 offen offset:1024 lds
    buffer_load_dwordx4 v18, s[48:51], s74 offen offset:2048 lds
    buffer_load_dwordx4 v19, s[48:51], s74 offen offset:3072 lds
    s_waitcnt vmcnt(16)
    s_barrier
    s_add_u32 m0, s30, 0
    s_add_u32 s74, s62, 230016
    buffer_load_dwordx4 v16, s[48:51], s74 offen lds
    buffer_load_dwordx4 v17, s[48:51], s74 offen offset:1024 lds
    buffer_load_dwordx4 v18, s[48:51], s74 offen offset:2048 lds
    buffer_load_dwordx4 v19, s[48:51], s74 offen offset:3072 lds
    s_waitcnt vmcnt(16)
    s_barrier
    s_add_u32 m0, s30, 16384
    s_add_u32 s74, s62, 344704
    buffer_load_dwordx4 v16, s[48:51], s74 offen lds
    buffer_load_dwordx4 v17, s[48:51], s74 offen offset:1024 lds
    buffer_load_dwordx4 v18, s[48:51], s74 offen offset:2048 lds
    buffer_load_dwordx4 v19, s[48:51], s74 offen offset:3072 lds
    s_waitcnt vmcnt(16)
    s_barrier
    s_add_u32 m0, s30, 98304
    s_add_u32 s74, s62, 768
    buffer_load_dwordx4 v16, s[48:51], s74 offen lds
    buffer_load_dwordx4 v17, s[48:51], s74 offen offset:1024 lds
    buffer_load_dwordx4 v18, s[48:51], s74 offen offset:2048 lds
    buffer_load_dwordx4 v19, s[48:51], s74 offen offset:3072 lds
    s_waitcnt vmcnt(16)
    s_barrier
    s_add_u32 m0, s30, 114688
    s_add_u32 s74, s62, 115456
    buffer_load_dwordx4 v16, s[48:51], s74 offen lds
    buffer_load_dwordx4 v17, s[48:51], s74 offen offset:1024 lds
    buffer_load_dwordx4 v18, s[48:51], s74 offen offset:2048 lds
    buffer_load_dwordx4 v19, s[48:51], s74 offen offset:3072 lds
    s_waitcnt vmcnt(16)
    s_barrier
    s_add_u32 m0, s30, 131072
    s_add_u32 s74, s62, 230144
    buffer_load_dwordx4 v16, s[48:51], s74 offen lds
    buffer_load_dwordx4 v17, s[48:51], s74 offen offset:1024 lds
    buffer_load_dwordx4 v18, s[48:51], s74 offen offset:2048 lds
    buffer_load_dwordx4 v19, s[48:51], s74 offen offset:3072 lds
    s_waitcnt vmcnt(16)
    s_barrier
    s_add_u32 m0, s30, 147456
    s_add_u32 s74, s62, 344832
    buffer_load_dwordx4 v16, s[48:51], s74 offen lds
    buffer_load_dwordx4 v17, s[48:51], s74 offen offset:1024 lds
    buffer_load_dwordx4 v18, s[48:51], s74 offen offset:2048 lds
    buffer_load_dwordx4 v19, s[48:51], s74 offen offset:3072 lds
    s_cmp_eq_u32 s3, 7
    v_mov_b32 v1, 0
    v_mov_b32 v3, 0
    s_cselect_b64 exec, 1, 0
    buffer_load_dword v3, v1, s[56:59], 0 offen sc1
    s_mov_b64 exec, -1
    s_waitcnt vmcnt(17)
    s_barrier
    s_waitcnt vmcnt(13)
    s_barrier
    s_waitcnt vmcnt(9)
    s_barrier
    s_waitcnt vmcnt(5)
    s_barrier
    s_waitcnt vmcnt(1)
    s_barrier
    s_barrier
    s_cmp_lg_u32 s3, 7
    s_cbranch_scc1 L_tail
    s_mov_b32 s73, 0x40000
    s_branch L_rchk
L_rpoll:
    buffer_load_dword v3, v1, s[56:59], 0 offen sc1
L_rchk:
    s_waitcnt vmcnt(0)
    v_readfirstlane_b32 s68, v3
    s_cmp_ge_u32 s68, 8
    s_cbranch_scc1 L_rpolled
    s_sleep 8
    s_sub_u32 s73, s73, 1
    s_cmp_lg_u32 s73, 0
    s_cbranch_scc1 L_rpoll
L_rpolled:
    s_lshl_b32 s68, s66, 8
    v_lshlrev_b32 v1, 2, v0
    v_add_u32 v1, s68, v1
    s_lshl_b32 s68, s66, 2
    v_lshlrev_b32 v4, 8, v0
    v_add_u32 v4, s68, v4
    v_mov_b32 v2, 1
    s_branch L_tail
L_compute:
    s_setprio 1
    s_lshl_b32 s68, s65, 19
    s_lshl_b32 s69, s66, 16
    s_add_u32 s68, s68, s69
    s_add_u32 s36, s6, s68
    s_addc_u32 s37, s7, 0
    s_and_b32 s37, s37, 0xffff
    s_mov_b32 s38, 65536
    s_mov_b32 s39, 0x20000
    s_add_u32 s40, s8, s68
    s_addc_u32 s41, s9, 0
    s_and_b32 s41, s41, 0xffff
    s_mov_b32 s42, 65536
    s_mov_b32 s43, 0x20000
    s_mul_i32 s68, s66, 458752
    s_add_u32 s48, s12, s68
    s_addc_u32 s49, s13, 0
    s_and_b32 s49, s49, 0xffff
    s_mov_b32 s50, 458752
    s_mov_b32 s51, 0x20000
    s_lshl_b32 s68, s64, 4
    s_add_u32 s68, s68, s65
    s_lshl_b32 s68, s68, 3
    s_add_u32 s68, s68, s66
    s_mul_i32 s68, s68, 57344
    s_add_u32 s52, s28, s68
    s_addc_u32 s53, s29, 0
    s_and_b32 s53, s53, 0xffff
    s_mov_b32 s54, 57344
    s_mov_b32 s55, 0x20000
    s_lshl_b32 s68, s64, 4
    s_add_u32 s68, s68, s65
    s_lshl_b32 s68, s68, 3
    s_add_u32 s56, s26, s68
    s_addc_u32 s57, s27, 0
    s_and_b32 s57, s57, 0xffff
    s_mov_b32 s58, 4
    s_mov_b32 s59, 0x20000
    s_lshl_b32 s68, s68, 8
    s_add_u32 s68, s68, 0x4000000
    s_add_u32 s16, s28, s68
    s_addc_u32 s17, s29, 0
    s_and_b32 s17, s17, 0xffff
    s_mov_b32 s18, 2048
    s_mov_b32 s19, 0x20000
    s_lshr_b32 s76, s3, 1
    s_and_b32 s77, s3, 1
    v_bfe_u32 v1, v0, 2, 2
    v_lshrrev_b32 v2, 5, v0
    v_bfe_u32 v3, v0, 4, 1
    v_and_b32 v4, 1, v0
    v_bfe_u32 v5, v0, 1, 1
    v_and_b32 v6, 31, v0
    v_lshlrev_b32 v7, 13, v2
    v_lshl_add_u32 v7, v1, 10, v7
    v_lshl_add_u32 v7, v3, 5, v7
    v_lshl_add_u32 v7, v4, 4, v7
    v_lshl_add_u32 v7, v5, 3, v7
    s_lshl_b32 s68, s76, 9
    v_add_u32 v7, s68, v7
    v_xor_b32 v8, 0, v1
    v_lshl_add_u32 v200, v8, 6, v7
    v_xor_b32 v8, 1, v1
    v_lshl_add_u32 v201, v8, 6, v7
    v_xor_b32 v8, 2, v1
    v_lshl_add_u32 v202, v8, 6, v7
    v_xor_b32 v8, 3, v1
    v_lshl_add_u32 v203, v8, 6, v7
    v_bfe_u32 v8, v0, 1, 3
    v_xor_b32 v8, v8, v2
    v_lshlrev_b32 v8, 4, v8
    v_lshl_add_u32 v8, v6, 7, v8
    s_lshl_b32 s68, s77, 12
    s_add_u32 s68, s68, 81920
    v_add_u32 v208, s68, v8
    v_and_b32 v8, 15, v0
    v_xor_b32 v8, v8, v2
    v_lshlrev_b32 v8, 4, v8
    v_lshl_add_u32 v8, v6, 9, v8
    s_lshl_b32 s69, s76, 15
    s_add_u32 s68, s69, 98304
    v_add_u32 v240, s68, v8
    v_lshlrev_b32 v7, 11, v2
    v_lshl_add_u32 v7, v1, 9, v7
    v_lshl_add_u32 v7, v3, 5, v7
    v_and_b32 v8, 3, v0
    v_lshl_add_u32 v7, v8, 3, v7
    v_add_u32 v7, s69, v7
    v_xor_b32 v8, 0, v1
    v_lshl_add_u32 v241, v8, 6, v7
    v_xor_b32 v8, 1, v1
    v_lshl_add_u32 v242, v8, 6, v7
    v_xor_b32 v8, 2, v1
    v_lshl_add_u32 v243, v8, 6, v7
    v_xor_b32 v8, 3, v1
    v_lshl_add_u32 v244, v8, 6, v7
    v_lshl_add_u32 v7, v2, 2, v1
    v_lshlrev_b32 v7, 7, v7
    v_lshl_add_u32 v7, v4, 5, v7
    v_lshl_add_u32 v7, v3, 4, v7
    v_lshl_add_u32 v7, v5, 3, v7
    v_lshrrev_b32 v8, 1, v1
    v_xor_b32 v8, s76, v8
    v_lshl_add_u32 v245, v8, 6, v7
    v_lshlrev_b32 v7, 4, v0
    s_lshl_b32 s68, s77, 14
    s_lshl_b32 s69, s76, 15
    s_sub_u32 s70, 65536, s69
    s_add_u32 s70, s70, s68
    v_add_u32 v247, s70, v7
    s_add_u32 s70, 32768, s69
    s_add_u32 s70, s70, s68
    v_add_u32 v248, s70, v7
    s_mul_i32 s68, s77, 14
    s_add_u32 s68, s68, s76
    s_lshl_b32 s68, s68, 11
    v_add_u32 v249, s68, v7
    s_cmp_eq_u32 s76, 0
    s_cselect_b64 s[8:9], -1, 0
    s_cmp_lg_u32 s3, 0
    s_cbranch_scc1 L_noreset
    s_lshl_b32 s68, s66, 8
    v_lshlrev_b32 v8, 2, v0
    v_mov_b32 v9, 0
    s_mov_b64 exec, 0xff
    buffer_store_dword v9, v8, s[16:19], s68 offen sc1
    s_mov_b64 exec, -1
L_noreset:
    s_cmp_lg_u32 s3, 1
    s_cbranch_scc1 L_notlb
    s_mul_i32 s68, s65, 114688
    s_add_u32 s60, s24, s68
    s_addc_u32 s61, s25, 0
    s_and_b32 s61, s61, 0xffff
    s_mov_b32 s62, 57344
    s_mov_b32 s63, 0x20000
    v_mov_b32 v9, 0
    buffer_load_dword v253, v9, s[52:55], 0 offen sc1
    buffer_load_dword v254, v9, s[60:63], 0 offen sc1
L_notlb:
    s_mov_b32 s11, 0
    v_add_u32 v204, 0x10000, v200
    v_add_u32 v205, 0x10000, v201
    v_add_u32 v206, 0x10000, v202
    v_add_u32 v207, 0x10000, v203
    v_xor_b32 v212, 0, v208
    v_xor_b32 v213, 32, v208
    v_xor_b32 v214, 64, v208
    v_xor_b32 v215, 96, v208
    s_barrier
    ds_read_b128 v[192:195], v212 offset:0
    ds_read_b64_tr_b16 v[128:129], v200 offset:0
    ds_read_b64_tr_b16 v[130:131], v200 offset:4096
    ds_read_b64_tr_b16 v[132:133], v201 offset:0
    ds_read_b64_tr_b16 v[134:135], v201 offset:4096
    ds_read_b64_tr_b16 v[136:137], v202 offset:0
    ds_read_b64_tr_b16 v[138:139], v202 offset:4096
    ds_read_b64_tr_b16 v[140:141], v203 offset:0
    ds_read_b64_tr_b16 v[142:143], v203 offset:4096
    ds_read_b64_tr_b16 v[144:145], v200 offset:256
    ds_read_b64_tr_b16 v[146:147], v200 offset:4352
    ds_read_b64_tr_b16 v[148:149], v201 offset:256
    ds_read_b64_tr_b16 v[150:151], v201 offset:4352
    ds_read_b64_tr_b16 v[152:153], v202 offset:256
    ds_read_b64_tr_b16 v[154:155], v202 offset:4352
    ds_read_b64_tr_b16 v[156:157], v203 offset:256
    ds_read_b64_tr_b16 v[158:159], v203 offset:4352
    s_waitcnt lgkmcnt(14)
    v_mfma_f32_32x32x16_bf16 v[0:15], v[128:131], v[192:195], 0
    s_waitcnt lgkmcnt(0)
    s_barrier
    v_mfma_f32_32x32x16_bf16 v[16:31], v[132:135], v[192:195], 0
    ds_read_b128 v[196:199], v213 offset:0
    ds_read_b64_tr_b16 v[160:161], v200 offset:16384
    ds_read_b64_tr_b16 v[162:163], v200 offset:20480
    v_mfma_f32_32x32x16_bf16 v[32:47], v[136:139], v[192:195], 0
    ds_read_b64_tr_b16 v[164:165], v201 offset:16384
    ds_read_b64_tr_b16 v[166:167], v201 offset:20480
    ds_read_b64_tr_b16 v[168:169], v202 offset:16384
    v_mfma_f32_32x32x16_bf16 v[48:63], v[140:143], v[192:195], 0
    ds_read_b64_tr_b16 v[170:171], v202 offset:20480
    ds_read_b64_tr_b16 v[172:173], v203 offset:16384
    ds_read_b64_tr_b16 v[174:175], v203 offset:20480
    v_mfma_f32_32x32x16_bf16 v[64:79], v[144:147], v[192:195], 0
    ds_read_b64_tr_b16 v[176:177], v200 offset:16640
    ds_read_b64_tr_b16 v[178:179], v200 offset:20736
    ds_read_b64_tr_b16 v[180:181], v201 offset:16640
    v_mfma_f32_32x32x16_bf16 v[80:95], v[148:151], v[192:195], 0
    ds_read_b64_tr_b16 v[182:183], v201 offset:20736
    ds_read_b64_tr_b16 v[184:185], v202 offset:16640
    ds_read_b64_tr_b16 v[186:187], v202 offset:20736
    v_mfma_f32_32x32x16_bf16 v[96:111], v[152:155], v[192:195], 0
    ds_read_b64_tr_b16 v[188:189], v203 offset:16640
    ds_read_b64_tr_b16 v[190:191], v203 offset:20736
    v_mfma_f32_32x32x16_bf16 v[112:127], v[156:159], v[192:195], 0
    s_waitcnt lgkmcnt(14)
    v_mfma_f32_32x32x16_bf16 v[0:15], v[160:163], v[196:199], v[0:15]
    s_waitcnt lgkmcnt(0)
    s_barrier
    v_mfma_f32_32x32x16_bf16 v[16:31], v[164:167], v[196:199], v[16:31]
    ds_read_b128 v[192:195], v214 offset:0
    ds_read_b64_tr_b16 v[128:129], v200 offset:32768
    ds_read_b64_tr_b16 v[130:131], v200 offset:36864
    v_mfma_f32_32x32x16_bf16 v[32:47], v[168:171], v[196:199], v[32:47]
    ds_read_b64_tr_b16 v[132:133], v201 offset:32768
    ds_read_b64_tr_b16 v[134:135], v201 offset:36864
    ds_read_b64_tr_b16 v[136:137], v202 offset:32768
    v_mfma_f32_32x32x16_bf16 v[48:63], v[172:175], v[196:199], v[48:63]
    ds_read_b64_tr_b16 v[138:139], v202 offset:36864
    ds_read_b64_tr_b16 v[140:141], v203 offset:32768
    ds_read_b64_tr_b16 v[142:143], v203 offset:36864
    v_mfma_f32_32x32x16_bf16 v[64:79], v[176:179], v[196:199], v[64:79]
    ds_read_b64_tr_b16 v[144:145], v200 offset:33024
    ds_read_b64_tr_b16 v[146:147], v200 offset:37120
    ds_read_b64_tr_b16 v[148:149], v201 offset:33024
    v_mfma_f32_32x32x16_bf16 v[80:95], v[180:183], v[196:199], v[80:95]
    ds_read_b64_tr_b16 v[150:151], v201 offset:37120
    ds_read_b64_tr_b16 v[152:153], v202 offset:33024
    ds_read_b64_tr_b16 v[154:155], v202 offset:37120
    v_mfma_f32_32x32x16_bf16 v[96:111], v[184:187], v[196:199], v[96:111]
    ds_read_b64_tr_b16 v[156:157], v203 offset:33024
    ds_read_b64_tr_b16 v[158:159], v203 offset:37120
    v_mfma_f32_32x32x16_bf16 v[112:127], v[188:191], v[196:199], v[112:127]
    s_waitcnt lgkmcnt(14)
    v_mfma_f32_32x32x16_bf16 v[0:15], v[128:131], v[192:195], v[0:15]
    s_waitcnt lgkmcnt(0)
    s_barrier
    v_mfma_f32_32x32x16_bf16 v[16:31], v[132:135], v[192:195], v[16:31]
    ds_read_b128 v[196:199], v215 offset:0
    ds_read_b64_tr_b16 v[160:161], v200 offset:49152
    ds_read_b64_tr_b16 v[162:163], v200 offset:53248
    v_mfma_f32_32x32x16_bf16 v[32:47], v[136:139], v[192:195], v[32:47]
    ds_read_b64_tr_b16 v[164:165], v201 offset:49152
    ds_read_b64_tr_b16 v[166:167], v201 offset:53248
    ds_read_b64_tr_b16 v[168:169], v202 offset:49152
    v_mfma_f32_32x32x16_bf16 v[48:63], v[140:143], v[192:195], v[48:63]
    ds_read_b64_tr_b16 v[170:171], v202 offset:53248
    ds_read_b64_tr_b16 v[172:173], v203 offset:49152
    ds_read_b64_tr_b16 v[174:175], v203 offset:53248
    v_mfma_f32_32x32x16_bf16 v[64:79], v[144:147], v[192:195], v[64:79]
    ds_read_b64_tr_b16 v[176:177], v200 offset:49408
    ds_read_b64_tr_b16 v[178:179], v200 offset:53504
    ds_read_b64_tr_b16 v[180:181], v201 offset:49408
    v_mfma_f32_32x32x16_bf16 v[80:95], v[148:151], v[192:195], v[80:95]
    ds_read_b64_tr_b16 v[182:183], v201 offset:53504
    ds_read_b64_tr_b16 v[184:185], v202 offset:49408
    ds_read_b64_tr_b16 v[186:187], v202 offset:53504
    v_mfma_f32_32x32x16_bf16 v[96:111], v[152:155], v[192:195], v[96:111]
    ds_read_b64_tr_b16 v[188:189], v203 offset:49408
    ds_read_b64_tr_b16 v[190:191], v203 offset:53504
    v_mfma_f32_32x32x16_bf16 v[112:127], v[156:159], v[192:195], v[112:127]
    s_waitcnt lgkmcnt(14)
    v_mfma_f32_32x32x16_bf16 v[0:15], v[160:163], v[196:199], v[0:15]
    s_waitcnt lgkmcnt(0)
    s_barrier
    v_mfma_f32_32x32x16_bf16 v[16:31], v[164:167], v[196:199], v[16:31]
    ds_read_b128 v[192:195], v212 offset:8192
    ds_read_b64_tr_b16 v[128:129], v204 offset:0
    ds_read_b64_tr_b16 v[130:131], v204 offset:4096
    v_mfma_f32_32x32x16_bf16 v[32:47], v[168:171], v[196:199], v[32:47]
    ds_read_b64_tr_b16 v[132:133], v205 offset:0
    ds_read_b64_tr_b16 v[134:135], v205 offset:4096
    ds_read_b64_tr_b16 v[136:137], v206 offset:0
    v_mfma_f32_32x32x16_bf16 v[48:63], v[172:175], v[196:199], v[48:63]
    ds_read_b64_tr_b16 v[138:139], v206 offset:4096
    ds_read_b64_tr_b16 v[140:141], v207 offset:0
    ds_read_b64_tr_b16 v[142:143], v207 offset:4096
    v_mfma_f32_32x32x16_bf16 v[64:79], v[176:179], v[196:199], v[64:79]
    ds_read_b64_tr_b16 v[144:145], v204 offset:256
    ds_read_b64_tr_b16 v[146:147], v204 offset:4352
    ds_read_b64_tr_b16 v[148:149], v205 offset:256
    v_mfma_f32_32x32x16_bf16 v[80:95], v[180:183], v[196:199], v[80:95]
    ds_read_b64_tr_b16 v[150:151], v205 offset:4352
    ds_read_b64_tr_b16 v[152:153], v206 offset:256
    ds_read_b64_tr_b16 v[154:155], v206 offset:4352
    v_mfma_f32_32x32x16_bf16 v[96:111], v[184:187], v[196:199], v[96:111]
    ds_read_b64_tr_b16 v[156:157], v207 offset:256
    ds_read_b64_tr_b16 v[158:159], v207 offset:4352
    v_mfma_f32_32x32x16_bf16 v[112:127], v[188:191], v[196:199], v[112:127]
    s_waitcnt lgkmcnt(14)
    v_mfma_f32_32x32x16_bf16 v[0:15], v[128:131], v[192:195], v[0:15]
    s_waitcnt lgkmcnt(0)
    s_barrier
    v_mfma_f32_32x32x16_bf16 v[16:31], v[132:135], v[192:195], v[16:31]
    ds_read_b128 v[196:199], v213 offset:8192
    ds_read_b64_tr_b16 v[160:161], v200 offset:0
    ds_read_b64_tr_b16 v[162:163], v200 offset:4096
    v_mfma_f32_32x32x16_bf16 v[32:47], v[136:139], v[192:195], v[32:47]
    ds_read_b64_tr_b16 v[164:165], v201 offset:0
    ds_read_b64_tr_b16 v[166:167], v201 offset:4096
    ds_read_b64_tr_b16 v[168:169], v202 offset:0
    v_mfma_f32_32x32x16_bf16 v[48:63], v[140:143], v[192:195], v[48:63]
    ds_read_b64_tr_b16 v[170:171], v202 offset:4096
    ds_read_b64_tr_b16 v[172:173], v203 offset:0
    ds_read_b64_tr_b16 v[174:175], v203 offset:4096
    v_mfma_f32_32x32x16_bf16 v[64:79], v[144:147], v[192:195], v[64:79]
    ds_read_b64_tr_b16 v[176:177], v200 offset:256
    ds_read_b64_tr_b16 v[178:179], v200 offset:4352
    ds_read_b64_tr_b16 v[180:181], v201 offset:256
    v_mfma_f32_32x32x16_bf16 v[80:95], v[148:151], v[192:195], v[80:95]
    ds_read_b64_tr_b16 v[182:183], v201 offset:4352
    ds_read_b64_tr_b16 v[184:185], v202 offset:256
    ds_read_b64_tr_b16 v[186:187], v202 offset:4352
    v_mfma_f32_32x32x16_bf16 v[96:111], v[152:155], v[192:195], v[96:111]
    ds_read_b64_tr_b16 v[188:189], v203 offset:256
    ds_read_b64_tr_b16 v[190:191], v203 offset:4352
    v_mfma_f32_32x32x16_bf16 v[112:127], v[156:159], v[192:195], v[112:127]
    s_waitcnt lgkmcnt(14)
    v_mfma_f32_32x32x16_bf16 v[0:15], v[160:163], v[196:199], v[0:15]
    s_waitcnt lgkmcnt(0)
    s_barrier
    v_mfma_f32_32x32x16_bf16 v[16:31], v[164:167], v[196:199], v[16:31]
    ds_read_b128 v[192:195], v214 offset:8192
    ds_read_b64_tr_b16 v[128:129], v200 offset:16384
    ds_read_b64_tr_b16 v[130:131], v200 offset:20480
    v_mfma_f32_32x32x16_bf16 v[32:47], v[168:171], v[196:199], v[32:47]
    ds_read_b64_tr_b16 v[132:133], v201 offset:16384
    ds_read_b64_tr_b16 v[134:135], v201 offset:20480
    ds_read_b64_tr_b16 v[136:137], v202 offset:16384
    v_mfma_f32_32x32x16_bf16 v[48:63], v[172:175], v[196:199], v[48:63]
    ds_read_b64_tr_b16 v[138:139], v202 offset:20480
    ds_read_b64_tr_b16 v[140:141], v203 offset:16384
    ds_read_b64_tr_b16 v[142:143], v203 offset:20480
    v_mfma_f32_32x32x16_bf16 v[64:79], v[176:179], v[196:199], v[64:79]
    ds_read_b64_tr_b16 v[144:145], v200 offset:16640
    ds_read_b64_tr_b16 v[146:147], v200 offset:20736
    ds_read_b64_tr_b16 v[148:149], v201 offset:16640
    v_mfma_f32_32x32x16_bf16 v[80:95], v[180:183], v[196:199], v[80:95]
    ds_read_b64_tr_b16 v[150:151], v201 offset:20736
    ds_read_b64_tr_b16 v[152:153], v202 offset:16640
    ds_read_b64_tr_b16 v[154:155], v202 offset:20736
    v_mfma_f32_32x32x16_bf16 v[96:111], v[184:187], v[196:199], v[96:111]
    ds_read_b64_tr_b16 v[156:157], v203 offset:16640
    ds_read_b64_tr_b16 v[158:159], v203 offset:20736
    v_mfma_f32_32x32x16_bf16 v[112:127], v[188:191], v[196:199], v[112:127]
    s_waitcnt lgkmcnt(14)
    v_mfma_f32_32x32x16_bf16 v[0:15], v[128:131], v[192:195], v[0:15]
    s_waitcnt lgkmcnt(0)
    s_barrier
    v_mfma_f32_32x32x16_bf16 v[16:31], v[132:135], v[192:195], v[16:31]
    ds_read_b128 v[196:199], v215 offset:8192
    ds_read_b64_tr_b16 v[160:161], v200 offset:32768
    ds_read_b64_tr_b16 v[162:163], v200 offset:36864
    v_mfma_f32_32x32x16_bf16 v[32:47], v[136:139], v[192:195], v[32:47]
    ds_read_b64_tr_b16 v[164:165], v201 offset:32768
    ds_read_b64_tr_b16 v[166:167], v201 offset:36864
    ds_read_b64_tr_b16 v[168:169], v202 offset:32768
    v_mfma_f32_32x32x16_bf16 v[48:63], v[140:143], v[192:195], v[48:63]
    ds_read_b64_tr_b16 v[170:171], v202 offset:36864
    ds_read_b64_tr_b16 v[172:173], v203 offset:32768
    ds_read_b64_tr_b16 v[174:175], v203 offset:36864
    v_mfma_f32_32x32x16_bf16 v[64:79], v[144:147], v[192:195], v[64:79]
    ds_read_b64_tr_b16 v[176:177], v200 offset:33024
    ds_read_b64_tr_b16 v[178:179], v200 offset:37120
    ds_read_b64_tr_b16 v[180:181], v201 offset:33024
    v_mfma_f32_32x32x16_bf16 v[80:95], v[148:151], v[192:195], v[80:95]
    ds_read_b64_tr_b16 v[182:183], v201 offset:37120
    ds_read_b64_tr_b16 v[184:185], v202 offset:33024
    ds_read_b64_tr_b16 v[186:187], v202 offset:37120
    v_mfma_f32_32x32x16_bf16 v[96:111], v[152:155], v[192:195], v[96:111]
    ds_read_b64_tr_b16 v[188:189], v203 offset:33024
    ds_read_b64_tr_b16 v[190:191], v203 offset:37120
    v_mfma_f32_32x32x16_bf16 v[112:127], v[156:159], v[192:195], v[112:127]
    s_waitcnt lgkmcnt(14)
    v_mfma_f32_32x32x16_bf16 v[0:15], v[160:163], v[196:199], v[0:15]
    s_waitcnt lgkmcnt(0)
    s_barrier
    v_mfma_f32_32x32x16_bf16 v[16:31], v[164:167], v[196:199], v[16:31]
    ds_read_b128 v[192:195], v212 offset:0
    ds_read_b64_tr_b16 v[128:129], v200 offset:49152
    ds_read_b64_tr_b16 v[130:131], v200 offset:53248
    v_mfma_f32_32x32x16_bf16 v[32:47], v[168:171], v[196:199], v[32:47]
    ds_read_b64_tr_b16 v[132:133], v201 offset:49152
    ds_read_b64_tr_b16 v[134:135], v201 offset:53248
    ds_read_b64_tr_b16 v[136:137], v202 offset:49152
    v_mfma_f32_32x32x16_bf16 v[48:63], v[172:175], v[196:199], v[48:63]
    ds_read_b64_tr_b16 v[138:139], v202 offset:53248
    ds_read_b64_tr_b16 v[140:141], v203 offset:49152
    ds_read_b64_tr_b16 v[142:143], v203 offset:53248
    v_mfma_f32_32x32x16_bf16 v[64:79], v[176:179], v[196:199], v[64:79]
    ds_read_b64_tr_b16 v[144:145], v200 offset:49408
    ds_read_b64_tr_b16 v[146:147], v200 offset:53504
    ds_read_b64_tr_b16 v[148:149], v201 offset:49408
    v_mfma_f32_32x32x16_bf16 v[80:95], v[180:183], v[196:199], v[80:95]
    ds_read_b64_tr_b16 v[150:151], v201 offset:53504
    ds_read_b64_tr_b16 v[152:153], v202 offset:49408
    ds_read_b64_tr_b16 v[154:155], v202 offset:53504
    v_mfma_f32_32x32x16_bf16 v[96:111], v[184:187], v[196:199], v[96:111]
    ds_read_b64_tr_b16 v[156:157], v203 offset:49408
    ds_read_b64_tr_b16 v[158:159], v203 offset:53504
    v_mfma_f32_32x32x16_bf16 v[112:127], v[188:191], v[196:199], v[112:127]
    s_waitcnt lgkmcnt(14)
    v_mfma_f32_32x32x16_bf16 v[0:15], v[128:131], v[192:195], v[0:15]
    s_waitcnt lgkmcnt(0)
    s_barrier
    v_mfma_f32_32x32x16_bf16 v[16:31], v[132:135], v[192:195], v[16:31]
    ds_read_b128 v[196:199], v213 offset:0
    ds_read_b64_tr_b16 v[160:161], v204 offset:0
    ds_read_b64_tr_b16 v[162:163], v204 offset:4096
    v_mfma_f32_32x32x16_bf16 v[32:47], v[136:139], v[192:195], v[32:47]
    ds_read_b64_tr_b16 v[164:165], v205 offset:0
    ds_read_b64_tr_b16 v[166:167], v205 offset:4096
    ds_read_b64_tr_b16 v[168:169], v206 offset:0
    v_mfma_f32_32x32x16_bf16 v[48:63], v[140:143], v[192:195], v[48:63]
    ds_read_b64_tr_b16 v[170:171], v206 offset:4096
    ds_read_b64_tr_b16 v[172:173], v207 offset:0
    ds_read_b64_tr_b16 v[174:175], v207 offset:4096
    v_mfma_f32_32x32x16_bf16 v[64:79], v[144:147], v[192:195], v[64:79]
    ds_read_b64_tr_b16 v[176:177], v204 offset:256
    ds_read_b64_tr_b16 v[178:179], v204 offset:4352
    ds_read_b64_tr_b16 v[180:181], v205 offset:256
    v_mfma_f32_32x32x16_bf16 v[80:95], v[148:151], v[192:195], v[80:95]
    ds_read_b64_tr_b16 v[182:183], v205 offset:4352
    ds_read_b64_tr_b16 v[184:185], v206 offset:256
    ds_read_b64_tr_b16 v[186:187], v206 offset:4352
    v_mfma_f32_32x32x16_bf16 v[96:111], v[152:155], v[192:195], v[96:111]
    ds_read_b64_tr_b16 v[188:189], v207 offset:256
    ds_read_b64_tr_b16 v[190:191], v207 offset:4352
    v_mfma_f32_32x32x16_bf16 v[112:127], v[156:159], v[192:195], v[112:127]
    s_waitcnt lgkmcnt(14)
    v_mfma_f32_32x32x16_bf16 v[0:15], v[160:163], v[196:199], v[0:15]
    s_waitcnt lgkmcnt(0)
    s_barrier
    v_mfma_f32_32x32x16_bf16 v[16:31], v[164:167], v[196:199], v[16:31]
    ds_read_b128 v[192:195], v214 offset:0
    ds_read_b64_tr_b16 v[128:129], v200 offset:0
    ds_read_b64_tr_b16 v[130:131], v200 offset:4096
    v_mfma_f32_32x32x16_bf16 v[32:47], v[168:171], v[196:199], v[32:47]
    ds_read_b64_tr_b16 v[132:133], v201 offset:0
    ds_read_b64_tr_b16 v[134:135], v201 offset:4096
    ds_read_b64_tr_b16 v[136:137], v202 offset:0
    v_mfma_f32_32x32x16_bf16 v[48:63], v[172:175], v[196:199], v[48:63]
    ds_read_b64_tr_b16 v[138:139], v202 offset:4096
    ds_read_b64_tr_b16 v[140:141], v203 offset:0
    ds_read_b64_tr_b16 v[142:143], v203 offset:4096
    v_mfma_f32_32x32x16_bf16 v[64:79], v[176:179], v[196:199], v[64:79]
    ds_read_b64_tr_b16 v[144:145], v200 offset:256
    ds_read_b64_tr_b16 v[146:147], v200 offset:4352
    ds_read_b64_tr_b16 v[148:149], v201 offset:256
    v_mfma_f32_32x32x16_bf16 v[80:95], v[180:183], v[196:199], v[80:95]
    ds_read_b64_tr_b16 v[150:151], v201 offset:4352
    ds_read_b64_tr_b16 v[152:153], v202 offset:256
    ds_read_b64_tr_b16 v[154:155], v202 offset:4352
    v_mfma_f32_32x32x16_bf16 v[96:111], v[184:187], v[196:199], v[96:111]
    ds_read_b64_tr_b16 v[156:157], v203 offset:256
    ds_read_b64_tr_b16 v[158:159], v203 offset:4352
    v_mfma_f32_32x32x16_bf16 v[112:127], v[188:191], v[196:199], v[112:127]
    s_waitcnt lgkmcnt(14)
    v_mfma_f32_32x32x16_bf16 v[0:15], v[128:131], v[192:195], v[0:15]
    s_waitcnt lgkmcnt(0)
    s_barrier
    v_mfma_f32_32x32x16_bf16 v[16:31], v[132:135], v[192:195], v[16:31]
    ds_read_b128 v[196:199], v215 offset:0
    ds_read_b64_tr_b16 v[160:161], v200 offset:16384
    ds_read_b64_tr_b16 v[162:163], v200 offset:20480
    v_mfma_f32_32x32x16_bf16 v[32:47], v[136:139], v[192:195], v[32:47]
    ds_read_b64_tr_b16 v[164:165], v201 offset:16384
    ds_read_b64_tr_b16 v[166:167], v201 offset:20480
    ds_read_b64_tr_b16 v[168:169], v202 offset:16384
    v_mfma_f32_32x32x16_bf16 v[48:63], v[140:143], v[192:195], v[48:63]
    ds_read_b64_tr_b16 v[170:171], v202 offset:20480
    ds_read_b64_tr_b16 v[172:173], v203 offset:16384
    ds_read_b64_tr_b16 v[174:175], v203 offset:20480
    v_mfma_f32_32x32x16_bf16 v[64:79], v[144:147], v[192:195], v[64:79]
    ds_read_b64_tr_b16 v[176:177], v200 offset:16640
    ds_read_b64_tr_b16 v[178:179], v200 offset:20736
    ds_read_b64_tr_b16 v[180:181], v201 offset:16640
    v_mfma_f32_32x32x16_bf16 v[80:95], v[148:151], v[192:195], v[80:95]
    ds_read_b64_tr_b16 v[182:183], v201 offset:20736
    ds_read_b64_tr_b16 v[184:185], v202 offset:16640
    ds_read_b64_tr_b16 v[186:187], v202 offset:20736
    v_mfma_f32_32x32x16_bf16 v[96:111], v[152:155], v[192:195], v[96:111]
    ds_read_b64_tr_b16 v[188:189], v203 offset:16640
    ds_read_b64_tr_b16 v[190:191], v203 offset:20736
    v_mfma_f32_32x32x16_bf16 v[112:127], v[156:159], v[192:195], v[112:127]
    s_waitcnt lgkmcnt(14)
    v_mfma_f32_32x32x16_bf16 v[0:15], v[160:163], v[196:199], v[0:15]
    s_waitcnt lgkmcnt(0)
    s_barrier
    v_mfma_f32_32x32x16_bf16 v[16:31], v[164:167], v[196:199], v[16:31]
    ds_read_b128 v[192:195], v212 offset:8192
    ds_read_b64_tr_b16 v[128:129], v200 offset:32768
    ds_read_b64_tr_b16 v[130:131], v200 offset:36864
    v_mfma_f32_32x32x16_bf16 v[32:47], v[168:171], v[196:199], v[32:47]
    ds_read_b64_tr_b16 v[132:133], v201 offset:32768
    ds_read_b64_tr_b16 v[134:135], v201 offset:36864
    ds_read_b64_tr_b16 v[136:137], v202 offset:32768
    v_mfma_f32_32x32x16_bf16 v[48:63], v[172:175], v[196:199], v[48:63]
    ds_read_b64_tr_b16 v[138:139], v202 offset:36864
    ds_read_b64_tr_b16 v[140:141], v203 offset:32768
    ds_read_b64_tr_b16 v[142:143], v203 offset:36864
    v_mfma_f32_32x32x16_bf16 v[64:79], v[176:179], v[196:199], v[64:79]
    ds_read_b64_tr_b16 v[144:145], v200 offset:33024
    ds_read_b64_tr_b16 v[146:147], v200 offset:37120
    ds_read_b64_tr_b16 v[148:149], v201 offset:33024
    v_mfma_f32_32x32x16_bf16 v[80:95], v[180:183], v[196:199], v[80:95]
    ds_read_b64_tr_b16 v[150:151], v201 offset:37120
    ds_read_b64_tr_b16 v[152:153], v202 offset:33024
    ds_read_b64_tr_b16 v[154:155], v202 offset:37120
    v_mfma_f32_32x32x16_bf16 v[96:111], v[184:187], v[196:199], v[96:111]
    ds_read_b64_tr_b16 v[156:157], v203 offset:33024
    ds_read_b64_tr_b16 v[158:159], v203 offset:37120
    v_mfma_f32_32x32x16_bf16 v[112:127], v[188:191], v[196:199], v[112:127]
    s_waitcnt lgkmcnt(14)
    v_mfma_f32_32x32x16_bf16 v[0:15], v[128:131], v[192:195], v[0:15]
    s_waitcnt lgkmcnt(0)
    s_barrier
    v_mfma_f32_32x32x16_bf16 v[16:31], v[132:135], v[192:195], v[16:31]
    ds_read_b128 v[196:199], v213 offset:8192
    ds_read_b64_tr_b16 v[160:161], v200 offset:49152
    ds_read_b64_tr_b16 v[162:163], v200 offset:53248
    v_mfma_f32_32x32x16_bf16 v[32:47], v[136:139], v[192:195], v[32:47]
    ds_read_b64_tr_b16 v[164:165], v201 offset:49152
    ds_read_b64_tr_b16 v[166:167], v201 offset:53248
    ds_read_b64_tr_b16 v[168:169], v202 offset:49152
    v_mfma_f32_32x32x16_bf16 v[48:63], v[140:143], v[192:195], v[48:63]
    ds_read_b64_tr_b16 v[170:171], v202 offset:53248
    ds_read_b64_tr_b16 v[172:173], v203 offset:49152
    ds_read_b64_tr_b16 v[174:175], v203 offset:53248
    v_mfma_f32_32x32x16_bf16 v[64:79], v[144:147], v[192:195], v[64:79]
    ds_read_b64_tr_b16 v[176:177], v200 offset:49408
    ds_read_b64_tr_b16 v[178:179], v200 offset:53504
    ds_read_b64_tr_b16 v[180:181], v201 offset:49408
    v_mfma_f32_32x32x16_bf16 v[80:95], v[148:151], v[192:195], v[80:95]
    ds_read_b64_tr_b16 v[182:183], v201 offset:53504
    ds_read_b64_tr_b16 v[184:185], v202 offset:49408
    ds_read_b64_tr_b16 v[186:187], v202 offset:53504
    v_mfma_f32_32x32x16_bf16 v[96:111], v[152:155], v[192:195], v[96:111]
    ds_read_b64_tr_b16 v[188:189], v203 offset:49408
    ds_read_b64_tr_b16 v[190:191], v203 offset:53504
    v_mfma_f32_32x32x16_bf16 v[112:127], v[156:159], v[192:195], v[112:127]
    s_waitcnt lgkmcnt(14)
    v_mfma_f32_32x32x16_bf16 v[0:15], v[160:163], v[196:199], v[0:15]
    s_waitcnt lgkmcnt(0)
    s_barrier
    v_mfma_f32_32x32x16_bf16 v[16:31], v[164:167], v[196:199], v[16:31]
    ds_read_b128 v[192:195], v214 offset:8192
    ds_read_b64_tr_b16 v[128:129], v204 offset:0
    ds_read_b64_tr_b16 v[130:131], v204 offset:4096
    v_mfma_f32_32x32x16_bf16 v[32:47], v[168:171], v[196:199], v[32:47]
    ds_read_b64_tr_b16 v[132:133], v205 offset:0
    ds_read_b64_tr_b16 v[134:135], v205 offset:4096
    ds_read_b64_tr_b16 v[136:137], v206 offset:0
    v_mfma_f32_32x32x16_bf16 v[48:63], v[172:175], v[196:199], v[48:63]
    ds_read_b64_tr_b16 v[138:139], v206 offset:4096
    ds_read_b64_tr_b16 v[140:141], v207 offset:0
    ds_read_b64_tr_b16 v[142:143], v207 offset:4096
    v_mfma_f32_32x32x16_bf16 v[64:79], v[176:179], v[196:199], v[64:79]
    ds_read_b64_tr_b16 v[144:145], v204 offset:256
    ds_read_b64_tr_b16 v[146:147], v204 offset:4352
    ds_read_b64_tr_b16 v[148:149], v205 offset:256
    v_mfma_f32_32x32x16_bf16 v[80:95], v[180:183], v[196:199], v[80:95]
    ds_read_b64_tr_b16 v[150:151], v205 offset:4352
    ds_read_b64_tr_b16 v[152:153], v206 offset:256
    ds_read_b64_tr_b16 v[154:155], v206 offset:4352
    v_mfma_f32_32x32x16_bf16 v[96:111], v[184:187], v[196:199], v[96:111]
    ds_read_b64_tr_b16 v[156:157], v207 offset:256
    ds_read_b64_tr_b16 v[158:159], v207 offset:4352
    v_mfma_f32_32x32x16_bf16 v[112:127], v[188:191], v[196:199], v[112:127]
    s_waitcnt lgkmcnt(14)
    v_mfma_f32_32x32x16_bf16 v[0:15], v[128:131], v[192:195], v[0:15]
    s_waitcnt lgkmcnt(0)
    s_barrier
    v_mfma_f32_32x32x16_bf16 v[16:31], v[132:135], v[192:195], v[16:31]
    ds_read_b128 v[196:199], v215 offset:8192
    ds_read_b64_tr_b16 v[160:161], v200 offset:0
    ds_read_b64_tr_b16 v[162:163], v200 offset:4096
    v_mfma_f32_32x32x16_bf16 v[32:47], v[136:139], v[192:195], v[32:47]
    ds_read_b64_tr_b16 v[164:165], v201 offset:0
    ds_read_b64_tr_b16 v[166:167], v201 offset:4096
    ds_read_b64_tr_b16 v[168:169], v202 offset:0
    v_mfma_f32_32x32x16_bf16 v[48:63], v[140:143], v[192:195], v[48:63]
    ds_read_b64_tr_b16 v[170:171], v202 offset:4096
    ds_read_b64_tr_b16 v[172:173], v203 offset:0
    ds_read_b64_tr_b16 v[174:175], v203 offset:4096
    v_mfma_f32_32x32x16_bf16 v[64:79], v[144:147], v[192:195], v[64:79]
    ds_read_b64_tr_b16 v[176:177], v200 offset:256
    ds_read_b64_tr_b16 v[178:179], v200 offset:4352
    ds_read_b64_tr_b16 v[180:181], v201 offset:256
    v_mfma_f32_32x32x16_bf16 v[80:95], v[148:151], v[192:195], v[80:95]
    ds_read_b64_tr_b16 v[182:183], v201 offset:4352
    ds_read_b64_tr_b16 v[184:185], v202 offset:256
    ds_read_b64_tr_b16 v[186:187], v202 offset:4352
    v_mfma_f32_32x32x16_bf16 v[96:111], v[152:155], v[192:195], v[96:111]
    ds_read_b64_tr_b16 v[188:189], v203 offset:256
    ds_read_b64_tr_b16 v[190:191], v203 offset:4352
    v_mfma_f32_32x32x16_bf16 v[112:127], v[156:159], v[192:195], v[112:127]
    s_waitcnt lgkmcnt(14)
    v_mfma_f32_32x32x16_bf16 v[0:15], v[160:163], v[196:199], v[0:15]
    s_waitcnt lgkmcnt(0)
    s_barrier
    v_mfma_f32_32x32x16_bf16 v[16:31], v[164:167], v[196:199], v[16:31]
    ds_read_b128 v[192:195], v212 offset:0
    ds_read_b64_tr_b16 v[128:129], v200 offset:16384
    ds_read_b64_tr_b16 v[130:131], v200 offset:20480
    v_mfma_f32_32x32x16_bf16 v[32:47], v[168:171], v[196:199], v[32:47]
    ds_read_b64_tr_b16 v[132:133], v201 offset:16384
    ds_read_b64_tr_b16 v[134:135], v201 offset:20480
    ds_read_b64_tr_b16 v[136:137], v202 offset:16384
    v_mfma_f32_32x32x16_bf16 v[48:63], v[172:175], v[196:199], v[48:63]
    ds_read_b64_tr_b16 v[138:139], v202 offset:20480
    ds_read_b64_tr_b16 v[140:141], v203 offset:16384
    ds_read_b64_tr_b16 v[142:143], v203 offset:20480
    v_mfma_f32_32x32x16_bf16 v[64:79], v[176:179], v[196:199], v[64:79]
    ds_read_b64_tr_b16 v[144:145], v200 offset:16640
    ds_read_b64_tr_b16 v[146:147], v200 offset:20736
    ds_read_b64_tr_b16 v[148:149], v201 offset:16640
    v_mfma_f32_32x32x16_bf16 v[80:95], v[180:183], v[196:199], v[80:95]
    ds_read_b64_tr_b16 v[150:151], v201 offset:20736
    ds_read_b64_tr_b16 v[152:153], v202 offset:16640
    ds_read_b64_tr_b16 v[154:155], v202 offset:20736
    v_mfma_f32_32x32x16_bf16 v[96:111], v[184:187], v[196:199], v[96:111]
    ds_read_b64_tr_b16 v[156:157], v203 offset:16640
    ds_read_b64_tr_b16 v[158:159], v203 offset:20736
    v_mfma_f32_32x32x16_bf16 v[112:127], v[188:191], v[196:199], v[112:127]
    s_waitcnt lgkmcnt(14)
    v_mfma_f32_32x32x16_bf16 v[0:15], v[128:131], v[192:195], v[0:15]
    s_waitcnt lgkmcnt(0)
    s_barrier
    v_mfma_f32_32x32x16_bf16 v[16:31], v[132:135], v[192:195], v[16:31]
    ds_read_b128 v[196:199], v213 offset:0
    ds_read_b64_tr_b16 v[160:161], v200 offset:32768
    ds_read_b64_tr_b16 v[162:163], v200 offset:36864
    v_mfma_f32_32x32x16_bf16 v[32:47], v[136:139], v[192:195], v[32:47]
    ds_read_b64_tr_b16 v[164:165], v201 offset:32768
    ds_read_b64_tr_b16 v[166:167], v201 offset:36864
    ds_read_b64_tr_b16 v[168:169], v202 offset:32768
    v_mfma_f32_32x32x16_bf16 v[48:63], v[140:143], v[192:195], v[48:63]
    ds_read_b64_tr_b16 v[170:171], v202 offset:36864
    ds_read_b64_tr_b16 v[172:173], v203 offset:32768
    ds_read_b64_tr_b16 v[174:175], v203 offset:36864
    v_mfma_f32_32x32x16_bf16 v[64:79], v[144:147], v[192:195], v[64:79]
    ds_read_b64_tr_b16 v[176:177], v200 offset:33024
    ds_read_b64_tr_b16 v[178:179], v200 offset:37120
    ds_read_b64_tr_b16 v[180:181], v201 offset:33024
    v_mfma_f32_32x32x16_bf16 v[80:95], v[148:151], v[192:195], v[80:95]
    ds_read_b64_tr_b16 v[182:183], v201 offset:37120
    ds_read_b64_tr_b16 v[184:185], v202 offset:33024
    ds_read_b64_tr_b16 v[186:187], v202 offset:37120
    v_mfma_f32_32x32x16_bf16 v[96:111], v[152:155], v[192:195], v[96:111]
    ds_read_b64_tr_b16 v[188:189], v203 offset:33024
    ds_read_b64_tr_b16 v[190:191], v203 offset:37120
    v_mfma_f32_32x32x16_bf16 v[112:127], v[156:159], v[192:195], v[112:127]
    s_waitcnt lgkmcnt(14)
    v_mfma_f32_32x32x16_bf16 v[0:15], v[160:163], v[196:199], v[0:15]
    s_waitcnt lgkmcnt(0)
    s_barrier
    v_mfma_f32_32x32x16_bf16 v[16:31], v[164:167], v[196:199], v[16:31]
    ds_read_b128 v[192:195], v214 offset:0
    ds_read_b64_tr_b16 v[128:129], v200 offset:49152
    ds_read_b64_tr_b16 v[130:131], v200 offset:53248
    v_mfma_f32_32x32x16_bf16 v[32:47], v[168:171], v[196:199], v[32:47]
    ds_read_b64_tr_b16 v[132:133], v201 offset:49152
    ds_read_b64_tr_b16 v[134:135], v201 offset:53248
    ds_read_b64_tr_b16 v[136:137], v202 offset:49152
    v_mfma_f32_32x32x16_bf16 v[48:63], v[172:175], v[196:199], v[48:63]
    ds_read_b64_tr_b16 v[138:139], v202 offset:53248
    ds_read_b64_tr_b16 v[140:141], v203 offset:49152
    ds_read_b64_tr_b16 v[142:143], v203 offset:53248
    v_mfma_f32_32x32x16_bf16 v[64:79], v[176:179], v[196:199], v[64:79]
    ds_read_b64_tr_b16 v[144:145], v200 offset:49408
    ds_read_b64_tr_b16 v[146:147], v200 offset:53504
    ds_read_b64_tr_b16 v[148:149], v201 offset:49408
    v_mfma_f32_32x32x16_bf16 v[80:95], v[180:183], v[196:199], v[80:95]
    ds_read_b64_tr_b16 v[150:151], v201 offset:53504
    ds_read_b64_tr_b16 v[152:153], v202 offset:49408
    ds_read_b64_tr_b16 v[154:155], v202 offset:53504
    v_mfma_f32_32x32x16_bf16 v[96:111], v[184:187], v[196:199], v[96:111]
    ds_read_b64_tr_b16 v[156:157], v203 offset:49408
    ds_read_b64_tr_b16 v[158:159], v203 offset:53504
    v_mfma_f32_32x32x16_bf16 v[112:127], v[188:191], v[196:199], v[112:127]
    s_waitcnt lgkmcnt(14)
    v_mfma_f32_32x32x16_bf16 v[0:15], v[128:131], v[192:195], v[0:15]
    s_waitcnt lgkmcnt(0)
    s_barrier
    v_mfma_f32_32x32x16_bf16 v[16:31], v[132:135], v[192:195], v[16:31]
    ds_read_b128 v[196:199], v215 offset:0
    ds_read_b64_tr_b16 v[160:161], v204 offset:0
    ds_read_b64_tr_b16 v[162:163], v204 offset:4096
    v_mfma_f32_32x32x16_bf16 v[32:47], v[136:139], v[192:195], v[32:47]
    ds_read_b64_tr_b16 v[164:165], v205 offset:0
    ds_read_b64_tr_b16 v[166:167], v205 offset:4096
    ds_read_b64_tr_b16 v[168:169], v206 offset:0
    v_mfma_f32_32x32x16_bf16 v[48:63], v[140:143], v[192:195], v[48:63]
    ds_read_b64_tr_b16 v[170:171], v206 offset:4096
    ds_read_b64_tr_b16 v[172:173], v207 offset:0
    ds_read_b64_tr_b16 v[174:175], v207 offset:4096
    v_mfma_f32_32x32x16_bf16 v[64:79], v[144:147], v[192:195], v[64:79]
    ds_read_b64_tr_b16 v[176:177], v204 offset:256
    ds_read_b64_tr_b16 v[178:179], v204 offset:4352
    ds_read_b64_tr_b16 v[180:181], v205 offset:256
    v_mfma_f32_32x32x16_bf16 v[80:95], v[148:151], v[192:195], v[80:95]
    ds_read_b64_tr_b16 v[182:183], v205 offset:4352
    ds_read_b64_tr_b16 v[184:185], v206 offset:256
    ds_read_b64_tr_b16 v[186:187], v206 offset:4352
    v_mfma_f32_32x32x16_bf16 v[96:111], v[152:155], v[192:195], v[96:111]
    ds_read_b64_tr_b16 v[188:189], v207 offset:256
    ds_read_b64_tr_b16 v[190:191], v207 offset:4352
    v_mfma_f32_32x32x16_bf16 v[112:127], v[156:159], v[192:195], v[112:127]
    s_waitcnt lgkmcnt(14)
    v_mfma_f32_32x32x16_bf16 v[0:15], v[160:163], v[196:199], v[0:15]
    s_waitcnt lgkmcnt(0)
    s_barrier
    v_mfma_f32_32x32x16_bf16 v[16:31], v[164:167], v[196:199], v[16:31]
    ds_read_b128 v[192:195], v212 offset:8192
    ds_read_b64_tr_b16 v[128:129], v200 offset:0
    ds_read_b64_tr_b16 v[130:131], v200 offset:4096
    v_mfma_f32_32x32x16_bf16 v[32:47], v[168:171], v[196:199], v[32:47]
    ds_read_b64_tr_b16 v[132:133], v201 offset:0
    ds_read_b64_tr_b16 v[134:135], v201 offset:4096
    ds_read_b64_tr_b16 v[136:137], v202 offset:0
    v_mfma_f32_32x32x16_bf16 v[48:63], v[172:175], v[196:199], v[48:63]
    ds_read_b64_tr_b16 v[138:139], v202 offset:4096
    ds_read_b64_tr_b16 v[140:141], v203 offset:0
    ds_read_b64_tr_b16 v[142:143], v203 offset:4096
    v_mfma_f32_32x32x16_bf16 v[64:79], v[176:179], v[196:199], v[64:79]
    ds_read_b64_tr_b16 v[144:145], v200 offset:256
    ds_read_b64_tr_b16 v[146:147], v200 offset:4352
    ds_read_b64_tr_b16 v[148:149], v201 offset:256
    v_mfma_f32_32x32x16_bf16 v[80:95], v[180:183], v[196:199], v[80:95]
    ds_read_b64_tr_b16 v[150:151], v201 offset:4352
    ds_read_b64_tr_b16 v[152:153], v202 offset:256
    ds_read_b64_tr_b16 v[154:155], v202 offset:4352
    v_mfma_f32_32x32x16_bf16 v[96:111], v[184:187], v[196:199], v[96:111]
    ds_read_b64_tr_b16 v[156:157], v203 offset:256
    ds_read_b64_tr_b16 v[158:159], v203 offset:4352
    v_mfma_f32_32x32x16_bf16 v[112:127], v[188:191], v[196:199], v[112:127]
    s_waitcnt lgkmcnt(14)
    v_mfma_f32_32x32x16_bf16 v[0:15], v[128:131], v[192:195], v[0:15]
    s_waitcnt lgkmcnt(0)
    s_barrier
    v_mfma_f32_32x32x16_bf16 v[16:31], v[132:135], v[192:195], v[16:31]
    ds_read_b128 v[196:199], v213 offset:8192
    ds_read_b64_tr_b16 v[160:161], v200 offset:16384
    ds_read_b64_tr_b16 v[162:163], v200 offset:20480
    v_mfma_f32_32x32x16_bf16 v[32:47], v[136:139], v[192:195], v[32:47]
    ds_read_b64_tr_b16 v[164:165], v201 offset:16384
    ds_read_b64_tr_b16 v[166:167], v201 offset:20480
    ds_read_b64_tr_b16 v[168:169], v202 offset:16384
    v_mfma_f32_32x32x16_bf16 v[48:63], v[140:143], v[192:195], v[48:63]
    ds_read_b64_tr_b16 v[170:171], v202 offset:20480
    ds_read_b64_tr_b16 v[172:173], v203 offset:16384
    ds_read_b64_tr_b16 v[174:175], v203 offset:20480
    v_mfma_f32_32x32x16_bf16 v[64:79], v[144:147], v[192:195], v[64:79]
    ds_read_b64_tr_b16 v[176:177], v200 offset:16640
    ds_read_b64_tr_b16 v[178:179], v200 offset:20736
    ds_read_b64_tr_b16 v[180:181], v201 offset:16640
    v_mfma_f32_32x32x16_bf16 v[80:95], v[148:151], v[192:195], v[80:95]
    ds_read_b64_tr_b16 v[182:183], v201 offset:20736
    ds_read_b64_tr_b16 v[184:185], v202 offset:16640
    ds_read_b64_tr_b16 v[186:187], v202 offset:20736
    v_mfma_f32_32x32x16_bf16 v[96:111], v[152:155], v[192:195], v[96:111]
    ds_read_b64_tr_b16 v[188:189], v203 offset:16640
    ds_read_b64_tr_b16 v[190:191], v203 offset:20736
    v_mfma_f32_32x32x16_bf16 v[112:127], v[156:159], v[192:195], v[112:127]
    s_waitcnt lgkmcnt(14)
    v_mfma_f32_32x32x16_bf16 v[0:15], v[160:163], v[196:199], v[0:15]
    s_waitcnt lgkmcnt(0)
    s_barrier
    v_mfma_f32_32x32x16_bf16 v[16:31], v[164:167], v[196:199], v[16:31]
    ds_read_b128 v[192:195], v214 offset:8192
    ds_read_b64_tr_b16 v[128:129], v200 offset:32768
    ds_read_b64_tr_b16 v[130:131], v200 offset:36864
    v_mfma_f32_32x32x16_bf16 v[32:47], v[168:171], v[196:199], v[32:47]
    ds_read_b64_tr_b16 v[132:133], v201 offset:32768
    ds_read_b64_tr_b16 v[134:135], v201 offset:36864
    ds_read_b64_tr_b16 v[136:137], v202 offset:32768
    v_mfma_f32_32x32x16_bf16 v[48:63], v[172:175], v[196:199], v[48:63]
    ds_read_b64_tr_b16 v[138:139], v202 offset:36864
    ds_read_b64_tr_b16 v[140:141], v203 offset:32768
    ds_read_b64_tr_b16 v[142:143], v203 offset:36864
    v_mfma_f32_32x32x16_bf16 v[64:79], v[176:179], v[196:199], v[64:79]
    ds_read_b64_tr_b16 v[144:145], v200 offset:33024
    ds_read_b64_tr_b16 v[146:147], v200 offset:37120
    ds_read_b64_tr_b16 v[148:149], v201 offset:33024
    v_mfma_f32_32x32x16_bf16 v[80:95], v[180:183], v[196:199], v[80:95]
    ds_read_b64_tr_b16 v[150:151], v201 offset:37120
    ds_read_b64_tr_b16 v[152:153], v202 offset:33024
    ds_read_b64_tr_b16 v[154:155], v202 offset:37120
    v_mfma_f32_32x32x16_bf16 v[96:111], v[184:187], v[196:199], v[96:111]
    ds_read_b64_tr_b16 v[156:157], v203 offset:33024
    ds_read_b64_tr_b16 v[158:159], v203 offset:37120
    v_mfma_f32_32x32x16_bf16 v[112:127], v[188:191], v[196:199], v[112:127]
    s_waitcnt lgkmcnt(14)
    v_mfma_f32_32x32x16_bf16 v[0:15], v[128:131], v[192:195], v[0:15]
    s_waitcnt lgkmcnt(0)
    s_barrier
    v_mfma_f32_32x32x16_bf16 v[16:31], v[132:135], v[192:195], v[16:31]
    ds_read_b128 v[196:199], v215 offset:8192
    ds_read_b64_tr_b16 v[160:161], v200 offset:49152
    ds_read_b64_tr_b16 v[162:163], v200 offset:53248
    v_mfma_f32_32x32x16_bf16 v[32:47], v[136:139], v[192:195], v[32:47]
    ds_read_b64_tr_b16 v[164:165], v201 offset:49152
    ds_read_b64_tr_b16 v[166:167], v201 offset:53248
    ds_read_b64_tr_b16 v[168:169], v202 offset:49152
    v_mfma_f32_32x32x16_bf16 v[48:63], v[140:143], v[192:195], v[48:63]
    ds_read_b64_tr_b16 v[170:171], v202 offset:53248
    ds_read_b64_tr_b16 v[172:173], v203 offset:49152
    ds_read_b64_tr_b16 v[174:175], v203 offset:53248
    v_mfma_f32_32x32x16_bf16 v[64:79], v[144:147], v[192:195], v[64:79]
    ds_read_b64_tr_b16 v[176:177], v200 offset:49408
    ds_read_b64_tr_b16 v[178:179], v200 offset:53504
    ds_read_b64_tr_b16 v[180:181], v201 offset:49408
    v_mfma_f32_32x32x16_bf16 v[80:95], v[148:151], v[192:195], v[80:95]
    ds_read_b64_tr_b16 v[182:183], v201 offset:53504
    ds_read_b64_tr_b16 v[184:185], v202 offset:49408
    ds_read_b64_tr_b16 v[186:187], v202 offset:53504
    v_mfma_f32_32x32x16_bf16 v[96:111], v[152:155], v[192:195], v[96:111]
    ds_read_b64_tr_b16 v[188:189], v203 offset:49408
    ds_read_b64_tr_b16 v[190:191], v203 offset:53504
    v_mfma_f32_32x32x16_bf16 v[112:127], v[156:159], v[192:195], v[112:127]
    s_waitcnt lgkmcnt(14)
    v_mfma_f32_32x32x16_bf16 v[0:15], v[160:163], v[196:199], v[0:15]
    s_waitcnt lgkmcnt(0)
    s_barrier
    v_mfma_f32_32x32x16_bf16 v[16:31], v[164:167], v[196:199], v[16:31]
    ds_read_b128 v[192:195], v212 offset:0
    ds_read_b64_tr_b16 v[128:129], v204 offset:0
    ds_read_b64_tr_b16 v[130:131], v204 offset:4096
    v_mfma_f32_32x32x16_bf16 v[32:47], v[168:171], v[196:199], v[32:47]
    ds_read_b64_tr_b16 v[132:133], v205 offset:0
    ds_read_b64_tr_b16 v[134:135], v205 offset:4096
    ds_read_b64_tr_b16 v[136:137], v206 offset:0
    v_mfma_f32_32x32x16_bf16 v[48:63], v[172:175], v[196:199], v[48:63]
    ds_read_b64_tr_b16 v[138:139], v206 offset:4096
    ds_read_b64_tr_b16 v[140:141], v207 offset:0
    ds_read_b64_tr_b16 v[142:143], v207 offset:4096
    v_mfma_f32_32x32x16_bf16 v[64:79], v[176:179], v[196:199], v[64:79]
    ds_read_b64_tr_b16 v[144:145], v204 offset:256
    ds_read_b64_tr_b16 v[146:147], v204 offset:4352
    ds_read_b64_tr_b16 v[148:149], v205 offset:256
    v_mfma_f32_32x32x16_bf16 v[80:95], v[180:183], v[196:199], v[80:95]
    ds_read_b64_tr_b16 v[150:151], v205 offset:4352
    ds_read_b64_tr_b16 v[152:153], v206 offset:256
    ds_read_b64_tr_b16 v[154:155], v206 offset:4352
    v_mfma_f32_32x32x16_bf16 v[96:111], v[184:187], v[196:199], v[96:111]
    ds_read_b64_tr_b16 v[156:157], v207 offset:256
    ds_read_b64_tr_b16 v[158:159], v207 offset:4352
    v_mfma_f32_32x32x16_bf16 v[112:127], v[188:191], v[196:199], v[112:127]
    s_waitcnt lgkmcnt(14)
    v_mfma_f32_32x32x16_bf16 v[0:15], v[128:131], v[192:195], v[0:15]
    s_waitcnt lgkmcnt(0)
    s_barrier
    v_mfma_f32_32x32x16_bf16 v[16:31], v[132:135], v[192:195], v[16:31]
    ds_read_b128 v[196:199], v213 offset:0
    ds_read_b64_tr_b16 v[160:161], v200 offset:0
    ds_read_b64_tr_b16 v[162:163], v200 offset:4096
    v_mfma_f32_32x32x16_bf16 v[32:47], v[136:139], v[192:195], v[32:47]
    ds_read_b64_tr_b16 v[164:165], v201 offset:0
    ds_read_b64_tr_b16 v[166:167], v201 offset:4096
    ds_read_b64_tr_b16 v[168:169], v202 offset:0
    v_mfma_f32_32x32x16_bf16 v[48:63], v[140:143], v[192:195], v[48:63]
    ds_read_b64_tr_b16 v[170:171], v202 offset:4096
    ds_read_b64_tr_b16 v[172:173], v203 offset:0
    ds_read_b64_tr_b16 v[174:175], v203 offset:4096
    v_mfma_f32_32x32x16_bf16 v[64:79], v[144:147], v[192:195], v[64:79]
    ds_read_b64_tr_b16 v[176:177], v200 offset:256
    ds_read_b64_tr_b16 v[178:179], v200 offset:4352
    ds_read_b64_tr_b16 v[180:181], v201 offset:256
    v_mfma_f32_32x32x16_bf16 v[80:95], v[148:151], v[192:195], v[80:95]
    ds_read_b64_tr_b16 v[182:183], v201 offset:4352
    ds_read_b64_tr_b16 v[184:185], v202 offset:256
    ds_read_b64_tr_b16 v[186:187], v202 offset:4352
    v_mfma_f32_32x32x16_bf16 v[96:111], v[152:155], v[192:195], v[96:111]
    ds_read_b64_tr_b16 v[188:189], v203 offset:256
    ds_read_b64_tr_b16 v[190:191], v203 offset:4352
    v_mfma_f32_32x32x16_bf16 v[112:127], v[156:159], v[192:195], v[112:127]
    s_waitcnt lgkmcnt(14)
    v_mfma_f32_32x32x16_bf16 v[0:15], v[160:163], v[196:199], v[0:15]
    s_waitcnt lgkmcnt(0)
    s_barrier
    v_mfma_f32_32x32x16_bf16 v[16:31], v[164:167], v[196:199], v[16:31]
    ds_read_b128 v[192:195], v214 offset:0
    ds_read_b64_tr_b16 v[128:129], v200 offset:16384
    ds_read_b64_tr_b16 v[130:131], v200 offset:20480
    v_mfma_f32_32x32x16_bf16 v[32:47], v[168:171], v[196:199], v[32:47]
    ds_read_b64_tr_b16 v[132:133], v201 offset:16384
    ds_read_b64_tr_b16 v[134:135], v201 offset:20480
    ds_read_b64_tr_b16 v[136:137], v202 offset:16384
    v_mfma_f32_32x32x16_bf16 v[48:63], v[172:175], v[196:199], v[48:63]
    ds_read_b64_tr_b16 v[138:139], v202 offset:20480
    ds_read_b64_tr_b16 v[140:141], v203 offset:16384
    ds_read_b64_tr_b16 v[142:143], v203 offset:20480
    v_mfma_f32_32x32x16_bf16 v[64:79], v[176:179], v[196:199], v[64:79]
    ds_read_b64_tr_b16 v[144:145], v200 offset:16640
    ds_read_b64_tr_b16 v[146:147], v200 offset:20736
    ds_read_b64_tr_b16 v[148:149], v201 offset:16640
    v_mfma_f32_32x32x16_bf16 v[80:95], v[180:183], v[196:199], v[80:95]
    ds_read_b64_tr_b16 v[150:151], v201 offset:20736
    ds_read_b64_tr_b16 v[152:153], v202 offset:16640
    ds_read_b64_tr_b16 v[154:155], v202 offset:20736
    v_mfma_f32_32x32x16_bf16 v[96:111], v[184:187], v[196:199], v[96:111]
    ds_read_b64_tr_b16 v[156:157], v203 offset:16640
    ds_read_b64_tr_b16 v[158:159], v203 offset:20736
    v_mfma_f32_32x32x16_bf16 v[112:127], v[188:191], v[196:199], v[112:127]
    s_waitcnt lgkmcnt(14)
    v_mfma_f32_32x32x16_bf16 v[0:15], v[128:131], v[192:195], v[0:15]
    s_waitcnt lgkmcnt(0)
    s_barrier
    v_mfma_f32_32x32x16_bf16 v[16:31], v[132:135], v[192:195], v[16:31]
    ds_read_b128 v[196:199], v215 offset:0
    ds_read_b64_tr_b16 v[160:161], v200 offset:32768
    ds_read_b64_tr_b16 v[162:163], v200 offset:36864
    v_mfma_f32_32x32x16_bf16 v[32:47], v[136:139], v[192:195], v[32:47]
    ds_read_b64_tr_b16 v[164:165], v201 offset:32768
    ds_read_b64_tr_b16 v[166:167], v201 offset:36864
    ds_read_b64_tr_b16 v[168:169], v202 offset:32768
    v_mfma_f32_32x32x16_bf16 v[48:63], v[140:143], v[192:195], v[48:63]
    ds_read_b64_tr_b16 v[170:171], v202 offset:36864
    ds_read_b64_tr_b16 v[172:173], v203 offset:32768
    ds_read_b64_tr_b16 v[174:175], v203 offset:36864
    v_mfma_f32_32x32x16_bf16 v[64:79], v[144:147], v[192:195], v[64:79]
    ds_read_b64_tr_b16 v[176:177], v200 offset:33024
    ds_read_b64_tr_b16 v[178:179], v200 offset:37120
    ds_read_b64_tr_b16 v[180:181], v201 offset:33024
    v_mfma_f32_32x32x16_bf16 v[80:95], v[148:151], v[192:195], v[80:95]
    ds_read_b64_tr_b16 v[182:183], v201 offset:37120
    ds_read_b64_tr_b16 v[184:185], v202 offset:33024
    ds_read_b64_tr_b16 v[186:187], v202 offset:37120
    v_mfma_f32_32x32x16_bf16 v[96:111], v[152:155], v[192:195], v[96:111]
    ds_read_b64_tr_b16 v[188:189], v203 offset:33024
    ds_read_b64_tr_b16 v[190:191], v203 offset:37120
    v_mfma_f32_32x32x16_bf16 v[112:127], v[156:159], v[192:195], v[112:127]
    s_waitcnt lgkmcnt(14)
    v_mfma_f32_32x32x16_bf16 v[0:15], v[160:163], v[196:199], v[0:15]
    s_waitcnt lgkmcnt(0)
    s_barrier
    v_mfma_f32_32x32x16_bf16 v[16:31], v[164:167], v[196:199], v[16:31]
    v_mfma_f32_32x32x16_bf16 v[32:47], v[168:171], v[196:199], v[32:47]
    v_mfma_f32_32x32x16_bf16 v[48:63], v[172:175], v[196:199], v[48:63]
    v_mfma_f32_32x32x16_bf16 v[64:79], v[176:179], v[196:199], v[64:79]
    v_mfma_f32_32x32x16_bf16 v[80:95], v[180:183], v[196:199], v[80:95]
    v_mfma_f32_32x32x16_bf16 v[96:111], v[184:187], v[196:199], v[96:111]
    v_mfma_f32_32x32x16_bf16 v[112:127], v[188:191], v[196:199], v[112:127]
    s_waitcnt vmcnt(0)
    s_cmp_lg_u32 s3, 0
    s_cbranch_scc1 L_nocnt
    v_mov_b32 v253, 0
    v_mov_b32 v254, 1
    s_mov_b64 exec, 1
    buffer_atomic_add v254, v253, s[56:59], 0 offen sc1
    s_mov_b64 exec, -1
L_nocnt:
L_S:
    s_waitcnt lgkmcnt(0)
    v_xor_b32 v250, 0, v240
    ds_read_b128 v[192:195], v250 offset:0
    ds_read_b128 v[196:199], v250 offset:16384
    v_xor_b32 v251, 32, v240
    ds_read_b128 v[200:203], v251 offset:0
    ds_read_b128 v[204:207], v251 offset:16384
    v_cvt_pk_bf16_f32 v128, v0, v1
    v_cvt_pk_bf16_f32 v129, v2, v3
    v_cvt_pk_bf16_f32 v130, v4, v5
    v_cvt_pk_bf16_f32 v131, v6, v7
    v_cvt_pk_bf16_f32 v132, v8, v9
    v_cvt_pk_bf16_f32 v133, v10, v11
    v_cvt_pk_bf16_f32 v134, v12, v13
    v_cvt_pk_bf16_f32 v135, v14, v15
    v_xor_b32 v250, 64, v240
    ds_read_b128 v[0:3], v250 offset:0
    ds_read_b128 v[4:7], v250 offset:16384
    v_xor_b32 v251, 96, v240
    ds_read_b128 v[8:11], v251 offset:0
    ds_read_b128 v[12:15], v251 offset:16384
    s_waitcnt lgkmcnt(6)
    v_mfma_f32_32x32x16_bf16 v[208:223], v[192:195], v[128:131], 0
    v_xor_b32 v250, 128, v240
    ds_read_b128 v[192:195], v250 offset:0
    v_mfma_f32_32x32x16_bf16 v[224:239], v[196:199], v[128:131], 0
    v_cvt_pk_bf16_f32 v136, v16, v17
    v_cvt_pk_bf16_f32 v137, v18, v19
    ds_read_b128 v[196:199], v250 offset:16384
    s_waitcnt lgkmcnt(6)
    v_mfma_f32_32x32x16_bf16 v[208:223], v[200:203], v[132:135], v[208:223]
    v_cvt_pk_bf16_f32 v138, v20, v21
    v_cvt_pk_bf16_f32 v139, v22, v23
    v_xor_b32 v251, 160, v240
    ds_read_b128 v[200:203], v251 offset:0
    v_mfma_f32_32x32x16_bf16 v[224:239], v[204:207], v[132:135], v[224:239]
    v_cvt_pk_bf16_f32 v140, v24, v25
    v_cvt_pk_bf16_f32 v141, v26, v27
    ds_read_b128 v[204:207], v251 offset:16384
    s_waitcnt lgkmcnt(6)
    v_mfma_f32_32x32x16_bf16 v[208:223], v[0:3], v[136:139], v[208:223]
    v_cvt_pk_bf16_f32 v142, v28, v29
    v_cvt_pk_bf16_f32 v143, v30, v31
    v_xor_b32 v250, 192, v240
    ds_read_b128 v[0:3], v250 offset:0
    v_mfma_f32_32x32x16_bf16 v[224:239], v[4:7], v[136:139], v[224:239]
    v_cvt_pk_bf16_f32 v144, v32, v33
    v_cvt_pk_bf16_f32 v145, v34, v35
    ds_read_b128 v[4:7], v250 offset:16384
    s_waitcnt lgkmcnt(6)
    v_mfma_f32_32x32x16_bf16 v[208:223], v[8:11], v[140:143], v[208:223]
    v_cvt_pk_bf16_f32 v146, v36, v37
    v_cvt_pk_bf16_f32 v147, v38, v39
    v_xor_b32 v251, 224, v240
    ds_read_b128 v[8:11], v251 offset:0
    v_mfma_f32_32x32x16_bf16 v[224:239], v[12:15], v[140:143], v[224:239]
    v_cvt_pk_bf16_f32 v148, v40, v41
    v_cvt_pk_bf16_f32 v149, v42, v43
    ds_read_b128 v[12:15], v251 offset:16384
    s_waitcnt lgkmcnt(6)
    v_mfma_f32_32x32x16_bf16 v[208:223], v[192:195], v[144:147], v[208:223]
    v_cvt_pk_bf16_f32 v150, v44, v45
    v_cvt_pk_bf16_f32 v151, v46, v47
    v_xor_b32 v250, 0, v240
    ds_read_b128 v[192:195], v250 offset:256
    v_mfma_f32_32x32x16_bf16 v[224:239], v[196:199], v[144:147], v[224:239]
    v_cvt_pk_bf16_f32 v152, v48, v49
    v_cvt_pk_bf16_f32 v153, v50, v51
    ds_read_b128 v[196:199], v250 offset:16640
    s_waitcnt lgkmcnt(6)
    v_mfma_f32_32x32x16_bf16 v[208:223], v[200:203], v[148:151], v[208:223]
    v_cvt_pk_bf16_f32 v154, v52, v53
    v_cvt_pk_bf16_f32 v155, v54, v55
    v_xor_b32 v251, 32, v240
    ds_read_b128 v[200:203], v251 offset:256
    v_mfma_f32_32x32x16_bf16 v[224:239], v[204:207], v[148:151], v[224:239]
    v_cvt_pk_bf16_f32 v156, v56, v57
    v_cvt_pk_bf16_f32 v157, v58, v59
    ds_read_b128 v[204:207], v251 offset:16640
    s_waitcnt lgkmcnt(6)
    v_mfma_f32_32x32x16_bf16 v[208:223], v[0:3], v[152:155], v[208:223]
    v_cvt_pk_bf16_f32 v158, v60, v61
    v_cvt_pk_bf16_f32 v159, v62, v63
    v_xor_b32 v250, 64, v240
    ds_read_b128 v[0:3], v250 offset:256
    v_mfma_f32_32x32x16_bf16 v[224:239], v[4:7], v[152:155], v[224:239]
    v_cvt_pk_bf16_f32 v160, v64, v65
    v_cvt_pk_bf16_f32 v161, v66, v67
    ds_read_b128 v[4:7], v250 offset:16640
    s_waitcnt lgkmcnt(6)
    v_mfma_f32_32x32x16_bf16 v[208:223], v[8:11], v[156:159], v[208:223]
    v_cvt_pk_bf16_f32 v162, v68, v69
    v_cvt_pk_bf16_f32 v163, v70, v71
    v_xor_b32 v251, 96, v240
    ds_read_b128 v[8:11], v251 offset:256
    v_mfma_f32_32x32x16_bf16 v[224:239], v[12:15], v[156:159], v[224:239]
    v_cvt_pk_bf16_f32 v164, v72, v73
    v_cvt_pk_bf16_f32 v165, v74, v75
    ds_read_b128 v[12:15], v251 offset:16640
    s_waitcnt lgkmcnt(6)
    v_mfma_f32_32x32x16_bf16 v[208:223], v[192:195], v[160:163], v[208:223]
    v_cvt_pk_bf16_f32 v166, v76, v77
    v_cvt_pk_bf16_f32 v167, v78, v79
    v_xor_b32 v250, 128, v240
    ds_read_b128 v[192:195], v250 offset:256
    v_mfma_f32_32x32x16_bf16 v[224:239], v[196:199], v[160:163], v[224:239]
    v_cvt_pk_bf16_f32 v168, v80, v81
    v_cvt_pk_bf16_f32 v169, v82, v83
    ds_read_b128 v[196:199], v250 offset:16640
    s_waitcnt lgkmcnt(6)
    v_mfma_f32_32x32x16_bf16 v[208:223], v[200:203], v[164:167], v[208:223]
    v_cvt_pk_bf16_f32 v170, v84, v85
    v_cvt_pk_bf16_f32 v171, v86, v87
    v_xor_b32 v251, 160, v240
    ds_read_b128 v[200:203], v251 offset:256
    v_mfma_f32_32x32x16_bf16 v[224:239], v[204:207], v[164:167], v[224:239]
    v_cvt_pk_bf16_f32 v172, v88, v89
    v_cvt_pk_bf16_f32 v173, v90, v91
    ds_read_b128 v[204:207], v251 offset:16640
    s_waitcnt lgkmcnt(6)
    v_mfma_f32_32x32x16_bf16 v[208:223], v[0:3], v[168:171], v[208:223]
    v_cvt_pk_bf16_f32 v174, v92, v93
    v_cvt_pk_bf16_f32 v175, v94, v95
    v_xor_b32 v250, 192, v240
    ds_read_b128 v[0:3], v250 offset:256
    v_mfma_f32_32x32x16_bf16 v[224:239], v[4:7], v[168:171], v[224:239]
    v_cvt_pk_bf16_f32 v176, v96, v97
    v_cvt_pk_bf16_f32 v177, v98, v99
    ds_read_b128 v[4:7], v250 offset:16640
    s_waitcnt lgkmcnt(6)
    v_mfma_f32_32x32x16_bf16 v[208:223], v[8:11], v[172:175], v[208:223]
    v_cvt_pk_bf16_f32 v178, v100, v101
    v_cvt_pk_bf16_f32 v179, v102, v103
    v_xor_b32 v251, 224, v240
    ds_read_b128 v[8:11], v251 offset:256
    v_mfma_f32_32x32x16_bf16 v[224:239], v[12:15], v[172:175], v[224:239]
    v_cvt_pk_bf16_f32 v180, v104, v105
    v_cvt_pk_bf16_f32 v181, v106, v107
    ds_read_b128 v[12:15], v251 offset:16640
    s_waitcnt lgkmcnt(6)
    v_mfma_f32_32x32x16_bf16 v[208:223], v[192:195], v[176:179], v[208:223]
    v_cvt_pk_bf16_f32 v182, v108, v109
    v_cvt_pk_bf16_f32 v183, v110, v111
    v_mfma_f32_32x32x16_bf16 v[224:239], v[196:199], v[176:179], v[224:239]
    v_cvt_pk_bf16_f32 v184, v112, v113
    v_cvt_pk_bf16_f32 v185, v114, v115
    s_waitcnt lgkmcnt(4)
    v_mfma_f32_32x32x16_bf16 v[208:223], v[200:203], v[180:183], v[208:223]
    v_cvt_pk_bf16_f32 v186, v116, v117
    v_cvt_pk_bf16_f32 v187, v118, v119
    v_mfma_f32_32x32x16_bf16 v[224:239], v[204:207], v[180:183], v[224:239]
    v_cvt_pk_bf16_f32 v188, v120, v121
    v_cvt_pk_bf16_f32 v189, v122, v123
    s_waitcnt lgkmcnt(2)
    v_mfma_f32_32x32x16_bf16 v[208:223], v[0:3], v[184:187], v[208:223]
    v_cvt_pk_bf16_f32 v190, v124, v125
    v_cvt_pk_bf16_f32 v191, v126, v127
    v_mfma_f32_32x32x16_bf16 v[224:239], v[4:7], v[184:187], v[224:239]
    s_waitcnt lgkmcnt(0)
    v_mfma_f32_32x32x16_bf16 v[208:223], v[8:11], v[188:191], v[208:223]
    v_mfma_f32_32x32x16_bf16 v[224:239], v[12:15], v[188:191], v[224:239]
    s_nop 7
    s_nop 3
    v_max3_f32 v250, v208, v209, v210
    v_max3_f32 v251, v224, v225, v226
    v_max3_f32 v250, v250, v211, v212
    v_max3_f32 v251, v251, v227, v228
    v_max3_f32 v250, v250, v213, v214
    v_max3_f32 v251, v251, v229, v230
    v_max3_f32 v250, v250, v215, v216
    v_max3_f32 v251, v251, v231, v232
    v_max3_f32 v250, v250, v217, v218
    v_max3_f32 v251, v251, v233, v234
    v_max3_f32 v250, v250, v219, v220
    v_max3_f32 v251, v251, v235, v236
    v_max3_f32 v250, v250, v221, v222
    v_max3_f32 v251, v251, v237, v238
    v_max3_f32 v250, v250, v223, v239
    v_max_f32 v250, v250, v251
    v_mov_b32 v251, v250
    s_nop 1
    v_permlane32_swap_b32 v250, v251
    s_nop 1
    v_max_f32 v250, v250, v251
    s_mov_b32 s12, 0x3db8aa3b
    v_mul_f32 v250, s12, v250
    v_pk_fma_f32 v[208:209], v[208:209], s[12:13], v[250:251] op_sel_hi:[1,0,0] neg_lo:[0,0,1] neg_hi:[0,0,1]
    v_pk_fma_f32 v[210:211], v[210:211], s[12:13], v[250:251] op_sel_hi:[1,0,0] neg_lo:[0,0,1] neg_hi:[0,0,1]
    v_exp_f32 v208, v208
    v_exp_f32 v209, v209
    v_pk_fma_f32 v[212:213], v[212:213], s[12:13], v[250:251] op_sel_hi:[1,0,0] neg_lo:[0,0,1] neg_hi:[0,0,1]
    v_exp_f32 v210, v210
    v_exp_f32 v211, v211
    v_pk_fma_f32 v[214:215], v[214:215], s[12:13], v[250:251] op_sel_hi:[1,0,0] neg_lo:[0,0,1] neg_hi:[0,0,1]
    v_exp_f32 v212, v212
    v_exp_f32 v213, v213
    v_pk_add_f32 v[252:253], v[208:209], v[210:211]
    v_pk_fma_f32 v[216:217], v[216:217], s[12:13], v[250:251] op_sel_hi:[1,0,0] neg_lo:[0,0,1] neg_hi:[0,0,1]
    v_exp_f32 v214, v214
    v_exp_f32 v215, v215
    v_pk_add_f32 v[252:253], v[252:253], v[212:213]
    v_pk_fma_f32 v[218:219], v[218:219], s[12:13], v[250:251] op_sel_hi:[1,0,0] neg_lo:[0,0,1] neg_hi:[0,0,1]
    v_exp_f32 v216, v216
    v_exp_f32 v217, v217
    v_pk_add_f32 v[252:253], v[252:253], v[214:215]
    v_pk_fma_f32 v[220:221], v[220:221], s[12:13], v[250:251] op_sel_hi:[1,0,0] neg_lo:[0,0,1] neg_hi:[0,0,1]
    v_exp_f32 v218, v218
    v_exp_f32 v219, v219
    v_pk_add_f32 v[252:253], v[252:253], v[216:217]
    v_pk_fma_f32 v[222:223], v[222:223], s[12:13], v[250:251] op_sel_hi:[1,0,0] neg_lo:[0,0,1] neg_hi:[0,0,1]
    v_exp_f32 v220, v220
    v_exp_f32 v221, v221
    v_pk_add_f32 v[252:253], v[252:253], v[218:219]
    v_pk_fma_f32 v[224:225], v[224:225], s[12:13], v[250:251] op_sel_hi:[1,0,0] neg_lo:[0,0,1] neg_hi:[0,0,1]
    v_exp_f32 v222, v222
    v_exp_f32 v223, v223
    v_pk_add_f32 v[252:253], v[252:253], v[220:221]
    v_pk_fma_f32 v[226:227], v[226:227], s[12:13], v[250:251] op_sel_hi:[1,0,0] neg_lo:[0,0,1] neg_hi:[0,0,1]
    v_exp_f32 v224, v224
    v_exp_f32 v225, v225
    v_pk_add_f32 v[252:253], v[252:253], v[222:223]
    v_pk_fma_f32 v[228:229], v[228:229], s[12:13], v[250:251] op_sel_hi:[1,0,0] neg_lo:[0,0,1] neg_hi:[0,0,1]
    v_exp_f32 v226, v226
    v_exp_f32 v227, v227
    v_pk_add_f32 v[252:253], v[252:253], v[224:225]
    v_pk_fma_f32 v[230:231], v[230:231], s[12:13], v[250:251] op_sel_hi:[1,0,0] neg_lo:[0,0,1] neg_hi:[0,0,1]
    v_exp_f32 v228, v228
    v_exp_f32 v229, v229
    v_pk_add_f32 v[252:253], v[252:253], v[226:227]
    v_pk_fma_f32 v[232:233], v[232:233], s[12:13], v[250:251] op_sel_hi:[1,0,0] neg_lo:[0,0,1] neg_hi:[0,0,1]
    v_exp_f32 v230, v230
    v_exp_f32 v231, v231
    v_pk_add_f32 v[252:253], v[252:253], v[228:229]
    v_pk_fma_f32 v[234:235], v[234:235], s[12:13], v[250:251] op_sel_hi:[1,0,0] neg_lo:[0,0,1] neg_hi:[0,0,1]
    v_exp_f32 v232, v232
    v_exp_f32 v233, v233
    v_pk_add_f32 v[252:253], v[252:253], v[230:231]
    v_pk_fma_f32 v[236:237], v[236:237], s[12:13], v[250:251] op_sel_hi:[1,0,0] neg_lo:[0,0,1] neg_hi:[0,0,1]
    v_exp_f32 v234, v234
    v_exp_f32 v235, v235
    v_pk_add_f32 v[252:253], v[252:253], v[232:233]
    v_pk_fma_f32 v[238:239], v[238:239], s[12:13], v[250:251] op_sel_hi:[1,0,0] neg_lo:[0,0,1] neg_hi:[0,0,1]
    v_exp_f32 v236, v236
    v_exp_f32 v237, v237
    v_pk_add_f32 v[252:253], v[252:253], v[234:235]
    v_exp_f32 v238, v238
    v_exp_f32 v239, v239
    v_pk_add_f32 v[252:253], v[252:253], v[236:237]
    s_nop 0
    v_pk_add_f32 v[252:253], v[252:253], v[238:239]
    v_add_f32 v250, v252, v253
    v_mov_b32 v251, v250
    s_nop 1
    v_permlane32_swap_b32 v250, v251
    s_nop 1
    v_add_f32 v250, v250, v251
    v_rcp_f32 v250, v250
    s_nop 0
    v_pk_mul_f32 v[208:209], v[208:209], v[250:251] op_sel_hi:[1,0]
    v_pk_mul_f32 v[210:211], v[210:211], v[250:251] op_sel_hi:[1,0]
    v_cvt_pk_bf16_f32 v192, v208, v209
    v_pk_mul_f32 v[212:213], v[212:213], v[250:251] op_sel_hi:[1,0]
    v_cvt_pk_bf16_f32 v193, v210, v211
    v_pk_mul_f32 v[214:215], v[214:215], v[250:251] op_sel_hi:[1,0]
    v_cvt_pk_bf16_f32 v194, v212, v213
    v_pk_mul_f32 v[216:217], v[216:217], v[250:251] op_sel_hi:[1,0]
    v_cvt_pk_bf16_f32 v195, v214, v215
    v_pk_mul_f32 v[218:219], v[218:219], v[250:251] op_sel_hi:[1,0]
    v_cvt_pk_bf16_f32 v196, v216, v217
    v_pk_mul_f32 v[220:221], v[220:221], v[250:251] op_sel_hi:[1,0]
    v_cvt_pk_bf16_f32 v197, v218, v219
    v_pk_mul_f32 v[222:223], v[222:223], v[250:251] op_sel_hi:[1,0]
    v_cvt_pk_bf16_f32 v198, v220, v221
    v_pk_mul_f32 v[224:225], v[224:225], v[250:251] op_sel_hi:[1,0]
    v_cvt_pk_bf16_f32 v199, v222, v223
    v_pk_mul_f32 v[226:227], v[226:227], v[250:251] op_sel_hi:[1,0]
    v_cvt_pk_bf16_f32 v200, v224, v225
    v_pk_mul_f32 v[228:229], v[228:229], v[250:251] op_sel_hi:[1,0]
    v_cvt_pk_bf16_f32 v201, v226, v227
    v_pk_mul_f32 v[230:231], v[230:231], v[250:251] op_sel_hi:[1,0]
    v_cvt_pk_bf16_f32 v202, v228, v229
    v_pk_mul_f32 v[232:233], v[232:233], v[250:251] op_sel_hi:[1,0]
    v_cvt_pk_bf16_f32 v203, v230, v231
    v_pk_mul_f32 v[234:235], v[234:235], v[250:251] op_sel_hi:[1,0]
    v_cvt_pk_bf16_f32 v204, v232, v233
    v_pk_mul_f32 v[236:237], v[236:237], v[250:251] op_sel_hi:[1,0]
    v_cvt_pk_bf16_f32 v205, v234, v235
    v_pk_mul_f32 v[238:239], v[238:239], v[250:251] op_sel_hi:[1,0]
    v_cvt_pk_bf16_f32 v206, v236, v237
    v_cvt_pk_bf16_f32 v207, v238, v239
    s_barrier
L_nob29:
    ds_read_b64_tr_b16 v[208:209], v241 offset:0
    ds_read_b64_tr_b16 v[210:211], v241 offset:4096
    ds_read_b64_tr_b16 v[212:213], v242 offset:0
    ds_read_b64_tr_b16 v[214:215], v242 offset:4096
    ds_read_b64_tr_b16 v[216:217], v241 offset:8192
    ds_read_b64_tr_b16 v[218:219], v241 offset:12288
    ds_read_b64_tr_b16 v[220:221], v242 offset:8192
    ds_read_b64_tr_b16 v[222:223], v242 offset:12288
    ds_read_b64_tr_b16 v[224:225], v241 offset:16384
    ds_read_b64_tr_b16 v[226:227], v241 offset:20480
    ds_read_b64_tr_b16 v[228:229], v242 offset:16384
    ds_read_b64_tr_b16 v[230:231], v242 offset:20480
    ds_read_b64_tr_b16 v[232:233], v241 offset:24576
    ds_read_b64_tr_b16 v[234:235], v241 offset:28672
L_pv1:
    s_waitcnt lgkmcnt(12)
    v_mfma_f32_32x32x16_bf16 v[0:15], v[208:211], v[192:195], 0
    ds_read_b64_tr_b16 v[236:237], v242 offset:24576
    ds_read_b64_tr_b16 v[238:239], v242 offset:28672
    s_waitcnt lgkmcnt(12)
    v_mfma_f32_32x32x16_bf16 v[16:31], v[212:215], v[192:195], 0
    ds_read_b64_tr_b16 v[208:209], v243 offset:0
    ds_read_b64_tr_b16 v[210:211], v243 offset:4096
    s_waitcnt lgkmcnt(12)
    v_mfma_f32_32x32x16_bf16 v[0:15], v[216:219], v[196:199], v[0:15]
    ds_read_b64_tr_b16 v[212:213], v244 offset:0
    ds_read_b64_tr_b16 v[214:215], v244 offset:4096
    s_waitcnt lgkmcnt(12)
    v_mfma_f32_32x32x16_bf16 v[16:31], v[220:223], v[196:199], v[16:31]
    ds_read_b64_tr_b16 v[216:217], v243 offset:8192
    ds_read_b64_tr_b16 v[218:219], v243 offset:12288
    s_waitcnt lgkmcnt(12)
    v_mfma_f32_32x32x16_bf16 v[0:15], v[224:227], v[200:203], v[0:15]
    ds_read_b64_tr_b16 v[220:221], v244 offset:8192
    ds_read_b64_tr_b16 v[222:223], v244 offset:12288
    s_waitcnt lgkmcnt(12)
    v_mfma_f32_32x32x16_bf16 v[16:31], v[228:231], v[200:203], v[16:31]
    ds_read_b64_tr_b16 v[224:225], v243 offset:16384
    ds_read_b64_tr_b16 v[226:227], v243 offset:20480
    s_waitcnt lgkmcnt(12)
    v_mfma_f32_32x32x16_bf16 v[0:15], v[232:235], v[204:207], v[0:15]
    ds_read_b64_tr_b16 v[228:229], v244 offset:16384
    ds_read_b64_tr_b16 v[230:231], v244 offset:20480
    s_waitcnt lgkmcnt(12)
    v_mfma_f32_32x32x16_bf16 v[16:31], v[236:239], v[204:207], v[16:31]
    ds_read_b64_tr_b16 v[232:233], v243 offset:24576
    ds_read_b64_tr_b16 v[234:235], v243 offset:28672
    s_waitcnt lgkmcnt(12)
    v_mfma_f32_32x32x16_bf16 v[32:47], v[208:211], v[192:195], 0
    ds_read_b64_tr_b16 v[236:237], v244 offset:24576
    ds_read_b64_tr_b16 v[238:239], v244 offset:28672
    v_cvt_pk_bf16_f32 v128, v0, v1
    v_cvt_pk_bf16_f32 v129, v2, v3
    s_waitcnt lgkmcnt(12)
    v_mfma_f32_32x32x16_bf16 v[48:63], v[212:215], v[192:195], 0
    ds_read_b64_tr_b16 v[208:209], v241 offset:256
    ds_read_b64_tr_b16 v[210:211], v241 offset:4352
    v_cvt_pk_bf16_f32 v130, v4, v5
    v_cvt_pk_bf16_f32 v131, v6, v7
    s_waitcnt lgkmcnt(12)
    v_mfma_f32_32x32x16_bf16 v[32:47], v[216:219], v[196:199], v[32:47]
    ds_read_b64_tr_b16 v[212:213], v242 offset:256
    ds_read_b64_tr_b16 v[214:215], v242 offset:4352
    v_cvt_pk_bf16_f32 v132, v8, v9
    v_cvt_pk_bf16_f32 v133, v10, v11
    s_waitcnt lgkmcnt(12)
    v_mfma_f32_32x32x16_bf16 v[48:63], v[220:223], v[196:199], v[48:63]
    ds_read_b64_tr_b16 v[216:217], v241 offset:8448
    ds_read_b64_tr_b16 v[218:219], v241 offset:12544
    v_cvt_pk_bf16_f32 v134, v12, v13
    v_cvt_pk_bf16_f32 v135, v14, v15
    s_waitcnt lgkmcnt(12)
    v_mfma_f32_32x32x16_bf16 v[32:47], v[224:227], v[200:203], v[32:47]
    ds_read_b64_tr_b16 v[220:221], v242 offset:8448
    ds_read_b64_tr_b16 v[222:223], v242 offset:12544
    v_cvt_pk_bf16_f32 v136, v16, v17
    v_cvt_pk_bf16_f32 v137, v18, v19
    s_waitcnt lgkmcnt(12)
    v_mfma_f32_32x32x16_bf16 v[48:63], v[228:231], v[200:203], v[48:63]
    ds_read_b64_tr_b16 v[224:225], v241 offset:16640
    ds_read_b64_tr_b16 v[226:227], v241 offset:20736
    v_cvt_pk_bf16_f32 v138, v20, v21
    v_cvt_pk_bf16_f32 v139, v22, v23
    s_waitcnt lgkmcnt(12)
    v_mfma_f32_32x32x16_bf16 v[32:47], v[232:235], v[204:207], v[32:47]
    ds_read_b64_tr_b16 v[228:229], v242 offset:16640
    ds_read_b64_tr_b16 v[230:231], v242 offset:20736
    v_cvt_pk_bf16_f32 v140, v24, v25
    v_cvt_pk_bf16_f32 v141, v26, v27
    s_waitcnt lgkmcnt(12)
    v_mfma_f32_32x32x16_bf16 v[48:63], v[236:239], v[204:207], v[48:63]
    ds_read_b64_tr_b16 v[232:233], v241 offset:24832
    ds_read_b64_tr_b16 v[234:235], v241 offset:28928
    v_cvt_pk_bf16_f32 v142, v28, v29
    v_cvt_pk_bf16_f32 v143, v30, v31
    s_waitcnt lgkmcnt(12)
    v_mfma_f32_32x32x16_bf16 v[64:79], v[208:211], v[192:195], 0
    ds_read_b64_tr_b16 v[236:237], v242 offset:24832
    ds_read_b64_tr_b16 v[238:239], v242 offset:28928
    v_cvt_pk_bf16_f32 v144, v32, v33
    v_cvt_pk_bf16_f32 v145, v34, v35
    s_waitcnt lgkmcnt(12)
    v_mfma_f32_32x32x16_bf16 v[80:95], v[212:215], v[192:195], 0
    ds_read_b64_tr_b16 v[208:209], v243 offset:256
    ds_read_b64_tr_b16 v[210:211], v243 offset:4352
    v_cvt_pk_bf16_f32 v146, v36, v37
    v_cvt_pk_bf16_f32 v147, v38, v39
    s_waitcnt lgkmcnt(12)
    v_mfma_f32_32x32x16_bf16 v[64:79], v[216:219], v[196:199], v[64:79]
    ds_read_b64_tr_b16 v[212:213], v244 offset:256
    ds_read_b64_tr_b16 v[214:215], v244 offset:4352
    v_cvt_pk_bf16_f32 v148, v40, v41
    v_cvt_pk_bf16_f32 v149, v42, v43
    s_waitcnt lgkmcnt(12)
    v_mfma_f32_32x32x16_bf16 v[80:95], v[220:223], v[196:199], v[80:95]
    ds_read_b64_tr_b16 v[216:217], v243 offset:8448
    ds_read_b64_tr_b16 v[218:219], v243 offset:12544
    v_cvt_pk_bf16_f32 v150, v44, v45
    v_cvt_pk_bf16_f32 v151, v46, v47
    s_waitcnt lgkmcnt(12)
    v_mfma_f32_32x32x16_bf16 v[64:79], v[224:227], v[200:203], v[64:79]
    ds_read_b64_tr_b16 v[220:221], v244 offset:8448
    ds_read_b64_tr_b16 v[222:223], v244 offset:12544
    v_cvt_pk_bf16_f32 v152, v48, v49
    v_cvt_pk_bf16_f32 v153, v50, v51
    s_waitcnt lgkmcnt(12)
    v_mfma_f32_32x32x16_bf16 v[80:95], v[228:231], v[200:203], v[80:95]
    ds_read_b64_tr_b16 v[224:225], v243 offset:16640
    ds_read_b64_tr_b16 v[226:227], v243 offset:20736
    v_cvt_pk_bf16_f32 v154, v52, v53
    v_cvt_pk_bf16_f32 v155, v54, v55
    s_waitcnt lgkmcnt(12)
    v_mfma_f32_32x32x16_bf16 v[64:79], v[232:235], v[204:207], v[64:79]
    ds_read_b64_tr_b16 v[228:229], v244 offset:16640
    ds_read_b64_tr_b16 v[230:231], v244 offset:20736
    v_cvt_pk_bf16_f32 v156, v56, v57
    v_cvt_pk_bf16_f32 v157, v58, v59
    s_waitcnt lgkmcnt(12)
    v_mfma_f32_32x32x16_bf16 v[80:95], v[236:239], v[204:207], v[80:95]
    ds_read_b64_tr_b16 v[232:233], v243 offset:24832
    ds_read_b64_tr_b16 v[234:235], v243 offset:28928
    v_cvt_pk_bf16_f32 v158, v60, v61
    v_cvt_pk_bf16_f32 v159, v62, v63
    s_waitcnt lgkmcnt(12)
    v_mfma_f32_32x32x16_bf16 v[96:111], v[208:211], v[192:195], 0
    ds_read_b64_tr_b16 v[236:237], v244 offset:24832
    ds_read_b64_tr_b16 v[238:239], v244 offset:28928
    v_cvt_pk_bf16_f32 v160, v64, v65
    v_cvt_pk_bf16_f32 v161, v66, v67
    s_waitcnt lgkmcnt(12)
    v_mfma_f32_32x32x16_bf16 v[112:127], v[212:215], v[192:195], 0
    v_cvt_pk_bf16_f32 v162, v68, v69
    v_cvt_pk_bf16_f32 v163, v70, v71
    s_waitcnt lgkmcnt(10)
    v_mfma_f32_32x32x16_bf16 v[96:111], v[216:219], v[196:199], v[96:111]
    v_cvt_pk_bf16_f32 v164, v72, v73
    v_cvt_pk_bf16_f32 v165, v74, v75
    s_waitcnt lgkmcnt(8)
    v_mfma_f32_32x32x16_bf16 v[112:127], v[220:223], v[196:199], v[112:127]
    v_cvt_pk_bf16_f32 v166, v76, v77
    v_cvt_pk_bf16_f32 v167, v78, v79
    s_waitcnt lgkmcnt(6)
    v_mfma_f32_32x32x16_bf16 v[96:111], v[224:227], v[200:203], v[96:111]
    v_cvt_pk_bf16_f32 v168, v80, v81
    v_cvt_pk_bf16_f32 v169, v82, v83
    s_waitcnt lgkmcnt(4)
    v_mfma_f32_32x32x16_bf16 v[112:127], v[228:231], v[200:203], v[112:127]
    v_cvt_pk_bf16_f32 v170, v84, v85
    v_cvt_pk_bf16_f32 v171, v86, v87
    s_waitcnt lgkmcnt(2)
    v_mfma_f32_32x32x16_bf16 v[96:111], v[232:235], v[204:207], v[96:111]
    v_cvt_pk_bf16_f32 v172, v88, v89
    v_cvt_pk_bf16_f32 v173, v90, v91
    s_waitcnt lgkmcnt(0)
    v_mfma_f32_32x32x16_bf16 v[112:127], v[236:239], v[204:207], v[112:127]
    v_cvt_pk_bf16_f32 v174, v92, v93
    v_cvt_pk_bf16_f32 v175, v94, v95
L_pvdone:
    s_waitcnt lgkmcnt(0)
    s_barrier
    s_mov_b32 s72, 98304
    v_add_u32 v246, s72, v245
    s_mov_b32 s10, 0
    s_mov_b32 s73, 3
    ds_read_b64_tr_b16 v[192:193], v246 offset:0
    ds_read_b64_tr_b16 v[194:195], v246 offset:1024
    ds_read_b64_tr_b16 v[196:197], v246 offset:2048
    ds_read_b64_tr_b16 v[198:199], v246 offset:3072
    ds_read_b64_tr_b16 v[200:201], v246 offset:4096
    ds_read_b64_tr_b16 v[202:203], v246 offset:5120
    ds_read_b64_tr_b16 v[204:205], v246 offset:6144
    ds_read_b64_tr_b16 v[206:207], v246 offset:7168
    ds_read_b64_tr_b16 v[208:209], v246 offset:8192
    ds_read_b64_tr_b16 v[210:211], v246 offset:9216
    ds_read_b64_tr_b16 v[212:213], v246 offset:10240
    ds_read_b64_tr_b16 v[214:215], v246 offset:11264
    ds_read_b64_tr_b16 v[216:217], v246 offset:12288
    ds_read_b64_tr_b16 v[218:219], v246 offset:13312
    ds_read_b64_tr_b16 v[220:221], v246 offset:14336
    ds_read_b64_tr_b16 v[222:223], v246 offset:15360
    s_add_u32 s72, s72, 16384
    s_cmp_eq_u32 s72, 163840
    s_cselect_b32 s72, 0, s72
    s_cmp_eq_u32 s72, 32768
    s_cselect_b32 s72, 98304, s72
    v_add_u32 v246, s72, v245
    ds_write_b128 v247, v[128:131] offset:0
    ds_write_b128 v247, v[132:135] offset:1024
    ds_write_b128 v247, v[136:139] offset:2048
    ds_write_b128 v247, v[140:143] offset:3072
    ds_write_b128 v247, v[144:147] offset:4096
    ds_write_b128 v247, v[148:151] offset:5120
    v_cvt_pk_bf16_f32 v176, v96, v97
    v_cvt_pk_bf16_f32 v177, v98, v99
    v_cvt_pk_bf16_f32 v178, v100, v101
    v_cvt_pk_bf16_f32 v179, v102, v103
    v_cvt_pk_bf16_f32 v180, v104, v105
    v_cvt_pk_bf16_f32 v181, v106, v107
    v_cvt_pk_bf16_f32 v182, v108, v109
    v_cvt_pk_bf16_f32 v183, v110, v111
    ds_write_b128 v247, v[152:155] offset:6144
    ds_write_b128 v247, v[156:159] offset:7168
    ds_write_b128 v247, v[160:163] offset:8192
    ds_write_b128 v247, v[164:167] offset:9216
    ds_write_b128 v247, v[168:171] offset:10240
    ds_write_b128 v247, v[172:175] offset:11264
    v_cvt_pk_bf16_f32 v184, v112, v113
    v_cvt_pk_bf16_f32 v185, v114, v115
    v_cvt_pk_bf16_f32 v186, v116, v117
    v_cvt_pk_bf16_f32 v187, v118, v119
    v_cvt_pk_bf16_f32 v188, v120, v121
    v_cvt_pk_bf16_f32 v189, v122, v123
    v_cvt_pk_bf16_f32 v190, v124, v125
    v_cvt_pk_bf16_f32 v191, v126, v127
    ds_write_b128 v247, v[176:179] offset:12288
    ds_write_b128 v247, v[180:183] offset:13312
    ds_write_b128 v247, v[184:187] offset:14336
    ds_write_b128 v247, v[188:191] offset:15360
    s_waitcnt lgkmcnt(0)
    s_barrier
    ds_read_b128 v[0:3], v248 offset:0
    ds_read_b128 v[4:7], v248 offset:1024
    ds_read_b128 v[8:11], v248 offset:2048
    ds_read_b128 v[12:15], v248 offset:3072
    ds_read_b128 v[16:19], v248 offset:4096
    ds_read_b128 v[20:23], v248 offset:5120
    ds_read_b128 v[24:27], v248 offset:6144
    ds_read_b128 v[28:31], v248 offset:7168
    ds_read_b128 v[32:35], v248 offset:8192
    ds_read_b128 v[36:39], v248 offset:9216
    ds_read_b128 v[40:43], v248 offset:10240
    ds_read_b128 v[44:47], v248 offset:11264
    ds_read_b128 v[48:51], v248 offset:12288
    ds_read_b128 v[52:55], v248 offset:13312
    ds_read_b128 v[56:59], v248 offset:14336
    ds_read_b128 v[60:63], v248 offset:15360
    s_cmp_eq_u32 s76, 0
    s_cbranch_scc0 L_oh1
    s_waitcnt lgkmcnt(14)
    v_mfma_f32_32x32x16_bf16 v[64:79], v[192:195], v[128:131], 0
    s_waitcnt lgkmcnt(0)
    s_barrier
    ds_read_b64_tr_b16 v[112:113], v246 offset:0
    v_mfma_f32_32x32x16_bf16 v[64:79], v[196:199], v[132:135], v[64:79]
    ds_read_b64_tr_b16 v[114:115], v246 offset:1024
    ds_read_b64_tr_b16 v[116:117], v246 offset:2048
    ds_read_b64_tr_b16 v[118:119], v246 offset:3072
    v_mfma_f32_32x32x16_bf16 v[64:79], v[200:203], v[136:139], v[64:79]
    ds_read_b64_tr_b16 v[120:121], v246 offset:4096
    ds_read_b64_tr_b16 v[122:123], v246 offset:5120
    ds_read_b64_tr_b16 v[124:125], v246 offset:6144
    v_mfma_f32_32x32x16_bf16 v[64:79], v[204:207], v[140:143], v[64:79]
    ds_read_b64_tr_b16 v[126:127], v246 offset:7168
    ds_read_b64_tr_b16 v[224:225], v246 offset:8192
    ds_read_b64_tr_b16 v[226:227], v246 offset:9216
    v_mfma_f32_32x32x16_bf16 v[64:79], v[208:211], v[144:147], v[64:79]
    ds_read_b64_tr_b16 v[228:229], v246 offset:10240
    ds_read_b64_tr_b16 v[230:231], v246 offset:11264
    ds_read_b64_tr_b16 v[232:233], v246 offset:12288
    v_mfma_f32_32x32x16_bf16 v[64:79], v[212:215], v[148:151], v[64:79]
    ds_read_b64_tr_b16 v[234:235], v246 offset:13312
    ds_read_b64_tr_b16 v[236:237], v246 offset:14336
    ds_read_b64_tr_b16 v[238:239], v246 offset:15360
    v_mfma_f32_32x32x16_bf16 v[64:79], v[216:219], v[152:155], v[64:79]
    s_add_u32 s72, s72, 16384
    s_cmp_eq_u32 s72, 163840
    s_cselect_b32 s72, 0, s72
    s_cmp_eq_u32 s72, 32768
    s_cselect_b32 s72, 98304, s72
    v_add_u32 v246, s72, v245
    v_mfma_f32_32x32x16_bf16 v[64:79], v[220:223], v[156:159], v[64:79]
    s_waitcnt lgkmcnt(14)
    v_mfma_f32_32x32x16_bf16 v[64:79], v[112:115], v[160:163], v[64:79]
    s_waitcnt lgkmcnt(0)
    s_barrier
    ds_read_b64_tr_b16 v[192:193], v246 offset:0
    v_mfma_f32_32x32x16_bf16 v[80:95], v[116:119], v[164:167], 0
    ds_read_b64_tr_b16 v[194:195], v246 offset:1024
    ds_read_b64_tr_b16 v[196:197], v246 offset:2048
    ds_read_b64_tr_b16 v[198:199], v246 offset:3072
    v_mfma_f32_32x32x16_bf16 v[64:79], v[120:123], v[168:171], v[64:79]
    ds_read_b64_tr_b16 v[200:201], v246 offset:4096
    ds_read_b64_tr_b16 v[202:203], v246 offset:5120
    ds_read_b64_tr_b16 v[204:205], v246 offset:6144
    v_mfma_f32_32x32x16_bf16 v[80:95], v[124:127], v[172:175], v[80:95]
    ds_read_b64_tr_b16 v[206:207], v246 offset:7168
    ds_read_b64_tr_b16 v[208:209], v246 offset:8192
    ds_read_b64_tr_b16 v[210:211], v246 offset:9216
    v_mfma_f32_32x32x16_bf16 v[64:79], v[224:227], v[176:179], v[64:79]
    ds_read_b64_tr_b16 v[212:213], v246 offset:10240
    ds_read_b64_tr_b16 v[214:215], v246 offset:11264
    ds_read_b64_tr_b16 v[216:217], v246 offset:12288
    v_mfma_f32_32x32x16_bf16 v[80:95], v[228:231], v[180:183], v[80:95]
    ds_read_b64_tr_b16 v[218:219], v246 offset:13312
    ds_read_b64_tr_b16 v[220:221], v246 offset:14336
    ds_read_b64_tr_b16 v[222:223], v246 offset:15360
    v_mfma_f32_32x32x16_bf16 v[64:79], v[232:235], v[184:187], v[64:79]
    s_add_u32 s72, s72, 16384
    s_cmp_eq_u32 s72, 163840
    s_cselect_b32 s72, 0, s72
    s_cmp_eq_u32 s72, 32768
    s_cselect_b32 s72, 98304, s72
    v_add_u32 v246, s72, v245
    v_mfma_f32_32x32x16_bf16 v[80:95], v[236:239], v[188:191], v[80:95]
    s_waitcnt lgkmcnt(14)
    v_mfma_f32_32x32x16_bf16 v[64:79], v[192:195], v[0:3], v[64:79]
    s_waitcnt lgkmcnt(0)
    s_barrier
    ds_read_b64_tr_b16 v[112:113], v246 offset:0
    v_mfma_f32_32x32x16_bf16 v[80:95], v[196:199], v[4:7], v[80:95]
    ds_read_b64_tr_b16 v[114:115], v246 offset:1024
    ds_read_b64_tr_b16 v[116:117], v246 offset:2048
    ds_read_b64_tr_b16 v[118:119], v246 offset:3072
    v_mfma_f32_32x32x16_bf16 v[64:79], v[200:203], v[8:11], v[64:79]
    ds_read_b64_tr_b16 v[120:121], v246 offset:4096
    ds_read_b64_tr_b16 v[122:123], v246 offset:5120
    ds_read_b64_tr_b16 v[124:125], v246 offset:6144
    v_mfma_f32_32x32x16_bf16 v[80:95], v[204:207], v[12:15], v[80:95]
    ds_read_b64_tr_b16 v[126:127], v246 offset:7168
    ds_read_b64_tr_b16 v[224:225], v246 offset:8192
    ds_read_b64_tr_b16 v[226:227], v246 offset:9216
    v_mfma_f32_32x32x16_bf16 v[64:79], v[208:211], v[16:19], v[64:79]
    ds_read_b64_tr_b16 v[228:229], v246 offset:10240
    ds_read_b64_tr_b16 v[230:231], v246 offset:11264
    ds_read_b64_tr_b16 v[232:233], v246 offset:12288
    v_mfma_f32_32x32x16_bf16 v[80:95], v[212:215], v[20:23], v[80:95]
    ds_read_b64_tr_b16 v[234:235], v246 offset:13312
    ds_read_b64_tr_b16 v[236:237], v246 offset:14336
    ds_read_b64_tr_b16 v[238:239], v246 offset:15360
    v_mfma_f32_32x32x16_bf16 v[64:79], v[216:219], v[24:27], v[64:79]
    s_add_u32 s72, s72, 16384
    s_cmp_eq_u32 s72, 163840
    s_cselect_b32 s72, 0, s72
    s_cmp_eq_u32 s72, 32768
    s_cselect_b32 s72, 98304, s72
    v_add_u32 v246, s72, v245
    v_mfma_f32_32x32x16_bf16 v[80:95], v[220:223], v[28:31], v[80:95]
    s_waitcnt lgkmcnt(14)
    v_mfma_f32_32x32x16_bf16 v[64:79], v[112:115], v[32:35], v[64:79]
    s_waitcnt lgkmcnt(0)
    s_barrier
    ds_read_b64_tr_b16 v[192:193], v246 offset:0
    v_mfma_f32_32x32x16_bf16 v[80:95], v[116:119], v[36:39], v[80:95]
    ds_read_b64_tr_b16 v[194:195], v246 offset:1024
    ds_read_b64_tr_b16 v[196:197], v246 offset:2048
    ds_read_b64_tr_b16 v[198:199], v246 offset:3072
    v_mfma_f32_32x32x16_bf16 v[64:79], v[120:123], v[40:43], v[64:79]
    ds_read_b64_tr_b16 v[200:201], v246 offset:4096
    ds_read_b64_tr_b16 v[202:203], v246 offset:5120
    ds_read_b64_tr_b16 v[204:205], v246 offset:6144
    v_mfma_f32_32x32x16_bf16 v[80:95], v[124:127], v[44:47], v[80:95]
    ds_read_b64_tr_b16 v[206:207], v246 offset:7168
    ds_read_b64_tr_b16 v[208:209], v246 offset:8192
    ds_read_b64_tr_b16 v[210:211], v246 offset:9216
    v_mfma_f32_32x32x16_bf16 v[64:79], v[224:227], v[48:51], v[64:79]
    ds_read_b64_tr_b16 v[212:213], v246 offset:10240
    ds_read_b64_tr_b16 v[214:215], v246 offset:11264
    ds_read_b64_tr_b16 v[216:217], v246 offset:12288
    v_mfma_f32_32x32x16_bf16 v[80:95], v[228:231], v[52:55], v[80:95]
    ds_read_b64_tr_b16 v[218:219], v246 offset:13312
    ds_read_b64_tr_b16 v[220:221], v246 offset:14336
    ds_read_b64_tr_b16 v[222:223], v246 offset:15360
    v_mfma_f32_32x32x16_bf16 v[64:79], v[232:235], v[56:59], v[64:79]
    s_add_u32 s72, s72, 16384
    s_cmp_eq_u32 s72, 163840
    s_cselect_b32 s72, 0, s72
    s_cmp_eq_u32 s72, 32768
    s_cselect_b32 s72, 98304, s72
    v_add_u32 v246, s72, v245
    v_mfma_f32_32x32x16_bf16 v[80:95], v[236:239], v[60:63], v[80:95]
L_oloop0:
    s_waitcnt lgkmcnt(14)
    v_mfma_f32_32x32x16_bf16 v[96:111], v[192:195], v[128:131], 0
    s_waitcnt lgkmcnt(0)
    s_barrier
    ds_read_b64_tr_b16 v[112:113], v246 offset:0
    v_mfma_f32_32x32x16_bf16 v[96:111], v[196:199], v[132:135], v[96:111]
    ds_read_b64_tr_b16 v[114:115], v246 offset:1024
    ds_read_b64_tr_b16 v[116:117], v246 offset:2048
    ds_read_b64_tr_b16 v[118:119], v246 offset:3072
    v_add_f32 v64, v64, v80
    v_add_f32 v65, v65, v81
    v_mfma_f32_32x32x16_bf16 v[96:111], v[200:203], v[136:139], v[96:111]
    ds_read_b64_tr_b16 v[120:121], v246 offset:4096
    ds_read_b64_tr_b16 v[122:123], v246 offset:5120
    ds_read_b64_tr_b16 v[124:125], v246 offset:6144
    v_add_f32 v66, v66, v82
    v_add_f32 v67, v67, v83
    v_mfma_f32_32x32x16_bf16 v[96:111], v[204:207], v[140:143], v[96:111]
    ds_read_b64_tr_b16 v[126:127], v246 offset:7168
    ds_read_b64_tr_b16 v[224:225], v246 offset:8192
    ds_read_b64_tr_b16 v[226:227], v246 offset:9216
    v_add_f32 v68, v68, v84
    v_add_f32 v69, v69, v85
    v_mfma_f32_32x32x16_bf16 v[96:111], v[208:211], v[144:147], v[96:111]
    ds_read_b64_tr_b16 v[228:229], v246 offset:10240
    ds_read_b64_tr_b16 v[230:231], v246 offset:11264
    ds_read_b64_tr_b16 v[232:233], v246 offset:12288
    v_add_f32 v70, v70, v86
    v_add_f32 v71, v71, v87
    v_mfma_f32_32x32x16_bf16 v[96:111], v[212:215], v[148:151], v[96:111]
    ds_read_b64_tr_b16 v[234:235], v246 offset:13312
    ds_read_b64_tr_b16 v[236:237], v246 offset:14336
    ds_read_b64_tr_b16 v[238:239], v246 offset:15360
    v_add_f32 v72, v72, v88
    v_add_f32 v73, v73, v89
    v_mfma_f32_32x32x16_bf16 v[96:111], v[216:219], v[152:155], v[96:111]
    s_add_u32 s72, s72, 16384
    s_cmp_eq_u32 s72, 163840
    s_cselect_b32 s72, 0, s72
    s_cmp_eq_u32 s72, 32768
    s_cselect_b32 s72, 98304, s72
    v_add_u32 v246, s72, v245
    v_add_f32 v74, v74, v90
    v_add_f32 v75, v75, v91
    v_mfma_f32_32x32x16_bf16 v[96:111], v[220:223], v[156:159], v[96:111]
    v_add_f32 v76, v76, v92
    v_add_f32 v77, v77, v93
    s_waitcnt lgkmcnt(14)
    v_mfma_f32_32x32x16_bf16 v[96:111], v[112:115], v[160:163], v[96:111]
    s_waitcnt lgkmcnt(0)
    s_barrier
    ds_read_b64_tr_b16 v[192:193], v246 offset:0
    v_add_f32 v78, v78, v94
    v_add_f32 v79, v79, v95
    v_mfma_f32_32x32x16_bf16 v[80:95], v[116:119], v[164:167], 0
    ds_read_b64_tr_b16 v[194:195], v246 offset:1024
    ds_read_b64_tr_b16 v[196:197], v246 offset:2048
    ds_read_b64_tr_b16 v[198:199], v246 offset:3072
    v_cvt_pk_bf16_f32 v64, v64, v65
    v_cvt_pk_bf16_f32 v65, v66, v67
    v_mfma_f32_32x32x16_bf16 v[96:111], v[120:123], v[168:171], v[96:111]
    ds_read_b64_tr_b16 v[200:201], v246 offset:4096
    ds_read_b64_tr_b16 v[202:203], v246 offset:5120
    ds_read_b64_tr_b16 v[204:205], v246 offset:6144
    v_cvt_pk_bf16_f32 v66, v68, v69
    v_cvt_pk_bf16_f32 v67, v70, v71
    v_mfma_f32_32x32x16_bf16 v[80:95], v[124:127], v[172:175], v[80:95]
    ds_read_b64_tr_b16 v[206:207], v246 offset:7168
    ds_read_b64_tr_b16 v[208:209], v246 offset:8192
    ds_read_b64_tr_b16 v[210:211], v246 offset:9216
    v_cvt_pk_bf16_f32 v68, v72, v73
    v_cvt_pk_bf16_f32 v69, v74, v75
    v_mfma_f32_32x32x16_bf16 v[96:111], v[224:227], v[176:179], v[96:111]
    ds_read_b64_tr_b16 v[212:213], v246 offset:10240
    ds_read_b64_tr_b16 v[214:215], v246 offset:11264
    ds_read_b64_tr_b16 v[216:217], v246 offset:12288
    v_cvt_pk_bf16_f32 v70, v76, v77
    v_cvt_pk_bf16_f32 v71, v78, v79
    v_mfma_f32_32x32x16_bf16 v[80:95], v[228:231], v[180:183], v[80:95]
    ds_read_b64_tr_b16 v[218:219], v246 offset:13312
    ds_read_b64_tr_b16 v[220:221], v246 offset:14336
    ds_read_b64_tr_b16 v[222:223], v246 offset:15360
    buffer_store_dwordx4 v[64:67], v249, s[52:55], s10 offen sc1
    buffer_store_dwordx4 v[68:71], v249, s[52:55], s10 offen offset:1024 sc1
    v_mfma_f32_32x32x16_bf16 v[96:111], v[232:235], v[184:187], v[96:111]
    s_add_u32 s72, s72, 16384
    s_cmp_eq_u32 s72, 163840
    s_cselect_b32 s72, 0, s72
    s_cmp_eq_u32 s72, 32768
    s_cselect_b32 s72, 98304, s72
    v_add_u32 v246, s72, v245
    s_add_u32 s10, s10, 4096
    v_mfma_f32_32x32x16_bf16 v[80:95], v[236:239], v[188:191], v[80:95]
    s_waitcnt lgkmcnt(14)
    v_mfma_f32_32x32x16_bf16 v[96:111], v[192:195], v[0:3], v[96:111]
    s_waitcnt lgkmcnt(0)
    s_barrier
    ds_read_b64_tr_b16 v[112:113], v246 offset:0
    v_mfma_f32_32x32x16_bf16 v[80:95], v[196:199], v[4:7], v[80:95]
    ds_read_b64_tr_b16 v[114:115], v246 offset:1024
    ds_read_b64_tr_b16 v[116:117], v246 offset:2048
    ds_read_b64_tr_b16 v[118:119], v246 offset:3072
    v_mfma_f32_32x32x16_bf16 v[96:111], v[200:203], v[8:11], v[96:111]
    ds_read_b64_tr_b16 v[120:121], v246 offset:4096
    ds_read_b64_tr_b16 v[122:123], v246 offset:5120
    ds_read_b64_tr_b16 v[124:125], v246 offset:6144
    v_mfma_f32_32x32x16_bf16 v[80:95], v[204:207], v[12:15], v[80:95]
    ds_read_b64_tr_b16 v[126:127], v246 offset:7168
    ds_read_b64_tr_b16 v[224:225], v246 offset:8192
    ds_read_b64_tr_b16 v[226:227], v246 offset:9216
    v_mfma_f32_32x32x16_bf16 v[96:111], v[208:211], v[16:19], v[96:111]
    ds_read_b64_tr_b16 v[228:229], v246 offset:10240
    ds_read_b64_tr_b16 v[230:231], v246 offset:11264
    ds_read_b64_tr_b16 v[232:233], v246 offset:12288
    v_mfma_f32_32x32x16_bf16 v[80:95], v[212:215], v[20:23], v[80:95]
    ds_read_b64_tr_b16 v[234:235], v246 offset:13312
    ds_read_b64_tr_b16 v[236:237], v246 offset:14336
    ds_read_b64_tr_b16 v[238:239], v246 offset:15360
    v_mfma_f32_32x32x16_bf16 v[96:111], v[216:219], v[24:27], v[96:111]
    s_add_u32 s72, s72, 16384
    s_cmp_eq_u32 s72, 163840
    s_cselect_b32 s72, 0, s72
    s_cmp_eq_u32 s72, 32768
    s_cselect_b32 s72, 98304, s72
    v_add_u32 v246, s72, v245
    v_mfma_f32_32x32x16_bf16 v[80:95], v[220:223], v[28:31], v[80:95]
    s_waitcnt lgkmcnt(14)
    v_mfma_f32_32x32x16_bf16 v[96:111], v[112:115], v[32:35], v[96:111]
    s_waitcnt lgkmcnt(0)
    s_barrier
    ds_read_b64_tr_b16 v[192:193], v246 offset:0
    v_mfma_f32_32x32x16_bf16 v[80:95], v[116:119], v[36:39], v[80:95]
    ds_read_b64_tr_b16 v[194:195], v246 offset:1024
    ds_read_b64_tr_b16 v[196:197], v246 offset:2048
    ds_read_b64_tr_b16 v[198:199], v246 offset:3072
    v_mfma_f32_32x32x16_bf16 v[96:111], v[120:123], v[40:43], v[96:111]
    ds_read_b64_tr_b16 v[200:201], v246 offset:4096
    ds_read_b64_tr_b16 v[202:203], v246 offset:5120
    ds_read_b64_tr_b16 v[204:205], v246 offset:6144
    v_mfma_f32_32x32x16_bf16 v[80:95], v[124:127], v[44:47], v[80:95]
    ds_read_b64_tr_b16 v[206:207], v246 offset:7168
    ds_read_b64_tr_b16 v[208:209], v246 offset:8192
    ds_read_b64_tr_b16 v[210:211], v246 offset:9216
    v_mfma_f32_32x32x16_bf16 v[96:111], v[224:227], v[48:51], v[96:111]
    ds_read_b64_tr_b16 v[212:213], v246 offset:10240
    ds_read_b64_tr_b16 v[214:215], v246 offset:11264
    ds_read_b64_tr_b16 v[216:217], v246 offset:12288
    v_mfma_f32_32x32x16_bf16 v[80:95], v[228:231], v[52:55], v[80:95]
    ds_read_b64_tr_b16 v[218:219], v246 offset:13312
    ds_read_b64_tr_b16 v[220:221], v246 offset:14336
    ds_read_b64_tr_b16 v[222:223], v246 offset:15360
    v_mfma_f32_32x32x16_bf16 v[96:111], v[232:235], v[56:59], v[96:111]
    s_add_u32 s72, s72, 16384
    s_cmp_eq_u32 s72, 163840
    s_cselect_b32 s72, 0, s72
    s_cmp_eq_u32 s72, 32768
    s_cselect_b32 s72, 98304, s72
    v_add_u32 v246, s72, v245
    v_mfma_f32_32x32x16_bf16 v[80:95], v[236:239], v[60:63], v[80:95]
    s_waitcnt lgkmcnt(14)
    v_mfma_f32_32x32x16_bf16 v[64:79], v[192:195], v[128:131], 0
    s_waitcnt lgkmcnt(0)
    s_barrier
    ds_read_b64_tr_b16 v[112:113], v246 offset:0
    v_mfma_f32_32x32x16_bf16 v[64:79], v[196:199], v[132:135], v[64:79]
    ds_read_b64_tr_b16 v[114:115], v246 offset:1024
    ds_read_b64_tr_b16 v[116:117], v246 offset:2048
    ds_read_b64_tr_b16 v[118:119], v246 offset:3072
    v_add_f32 v96, v96, v80
    v_add_f32 v97, v97, v81
    v_mfma_f32_32x32x16_bf16 v[64:79], v[200:203], v[136:139], v[64:79]
    ds_read_b64_tr_b16 v[120:121], v246 offset:4096
    ds_read_b64_tr_b16 v[122:123], v246 offset:5120
    ds_read_b64_tr_b16 v[124:125], v246 offset:6144
    v_add_f32 v98, v98, v82
    v_add_f32 v99, v99, v83
    v_mfma_f32_32x32x16_bf16 v[64:79], v[204:207], v[140:143], v[64:79]
    ds_read_b64_tr_b16 v[126:127], v246 offset:7168
    ds_read_b64_tr_b16 v[224:225], v246 offset:8192
    ds_read_b64_tr_b16 v[226:227], v246 offset:9216
    v_add_f32 v100, v100, v84
    v_add_f32 v101, v101, v85
    v_mfma_f32_32x32x16_bf16 v[64:79], v[208:211], v[144:147], v[64:79]
    ds_read_b64_tr_b16 v[228:229], v246 offset:10240
    ds_read_b64_tr_b16 v[230:231], v246 offset:11264
    ds_read_b64_tr_b16 v[232:233], v246 offset:12288
    v_add_f32 v102, v102, v86
    v_add_f32 v103, v103, v87
    v_mfma_f32_32x32x16_bf16 v[64:79], v[212:215], v[148:151], v[64:79]
    ds_read_b64_tr_b16 v[234:235], v246 offset:13312
    ds_read_b64_tr_b16 v[236:237], v246 offset:14336
    ds_read_b64_tr_b16 v[238:239], v246 offset:15360
    v_add_f32 v104, v104, v88
    v_add_f32 v105, v105, v89
    v_mfma_f32_32x32x16_bf16 v[64:79], v[216:219], v[152:155], v[64:79]
    s_add_u32 s72, s72, 16384
    s_cmp_eq_u32 s72, 163840
    s_cselect_b32 s72, 0, s72
    s_cmp_eq_u32 s72, 32768
    s_cselect_b32 s72, 98304, s72
    v_add_u32 v246, s72, v245
    v_add_f32 v106, v106, v90
    v_add_f32 v107, v107, v91
    v_mfma_f32_32x32x16_bf16 v[64:79], v[220:223], v[156:159], v[64:79]
    v_add_f32 v108, v108, v92
    v_add_f32 v109, v109, v93
    s_waitcnt lgkmcnt(14)
    v_mfma_f32_32x32x16_bf16 v[64:79], v[112:115], v[160:163], v[64:79]
    s_waitcnt lgkmcnt(0)
    s_barrier
    ds_read_b64_tr_b16 v[192:193], v246 offset:0
    v_add_f32 v110, v110, v94
    v_add_f32 v111, v111, v95
    v_mfma_f32_32x32x16_bf16 v[80:95], v[116:119], v[164:167], 0
    ds_read_b64_tr_b16 v[194:195], v246 offset:1024
    ds_read_b64_tr_b16 v[196:197], v246 offset:2048
    ds_read_b64_tr_b16 v[198:199], v246 offset:3072
    v_cvt_pk_bf16_f32 v96, v96, v97
    v_cvt_pk_bf16_f32 v97, v98, v99
    v_mfma_f32_32x32x16_bf16 v[64:79], v[120:123], v[168:171], v[64:79]
    ds_read_b64_tr_b16 v[200:201], v246 offset:4096
    ds_read_b64_tr_b16 v[202:203], v246 offset:5120
    ds_read_b64_tr_b16 v[204:205], v246 offset:6144
    v_cvt_pk_bf16_f32 v98, v100, v101
    v_cvt_pk_bf16_f32 v99, v102, v103
    v_mfma_f32_32x32x16_bf16 v[80:95], v[124:127], v[172:175], v[80:95]
    ds_read_b64_tr_b16 v[206:207], v246 offset:7168
    ds_read_b64_tr_b16 v[208:209], v246 offset:8192
    ds_read_b64_tr_b16 v[210:211], v246 offset:9216
    v_cvt_pk_bf16_f32 v100, v104, v105
    v_cvt_pk_bf16_f32 v101, v106, v107
    v_mfma_f32_32x32x16_bf16 v[64:79], v[224:227], v[176:179], v[64:79]
    ds_read_b64_tr_b16 v[212:213], v246 offset:10240
    ds_read_b64_tr_b16 v[214:215], v246 offset:11264
    ds_read_b64_tr_b16 v[216:217], v246 offset:12288
    v_cvt_pk_bf16_f32 v102, v108, v109
    v_cvt_pk_bf16_f32 v103, v110, v111
    v_mfma_f32_32x32x16_bf16 v[80:95], v[228:231], v[180:183], v[80:95]
    ds_read_b64_tr_b16 v[218:219], v246 offset:13312
    ds_read_b64_tr_b16 v[220:221], v246 offset:14336
    ds_read_b64_tr_b16 v[222:223], v246 offset:15360
    buffer_store_dwordx4 v[96:99], v249, s[52:55], s10 offen sc1
    buffer_store_dwordx4 v[100:103], v249, s[52:55], s10 offen offset:1024 sc1
    v_mfma_f32_32x32x16_bf16 v[64:79], v[232:235], v[184:187], v[64:79]
    s_add_u32 s72, s72, 16384
    s_cmp_eq_u32 s72, 163840
    s_cselect_b32 s72, 0, s72
    s_cmp_eq_u32 s72, 32768
    s_cselect_b32 s72, 98304, s72
    v_add_u32 v246, s72, v245
    s_add_u32 s10, s10, 4096
    v_mfma_f32_32x32x16_bf16 v[80:95], v[236:239], v[188:191], v[80:95]
    s_waitcnt lgkmcnt(14)
    v_mfma_f32_32x32x16_bf16 v[64:79], v[192:195], v[0:3], v[64:79]
    s_waitcnt lgkmcnt(0)
    s_barrier
    ds_read_b64_tr_b16 v[112:113], v246 offset:0
    v_mfma_f32_32x32x16_bf16 v[80:95], v[196:199], v[4:7], v[80:95]
    ds_read_b64_tr_b16 v[114:115], v246 offset:1024
    ds_read_b64_tr_b16 v[116:117], v246 offset:2048
    ds_read_b64_tr_b16 v[118:119], v246 offset:3072
    v_mfma_f32_32x32x16_bf16 v[64:79], v[200:203], v[8:11], v[64:79]
    ds_read_b64_tr_b16 v[120:121], v246 offset:4096
    ds_read_b64_tr_b16 v[122:123], v246 offset:5120
    ds_read_b64_tr_b16 v[124:125], v246 offset:6144
    v_mfma_f32_32x32x16_bf16 v[80:95], v[204:207], v[12:15], v[80:95]
    ds_read_b64_tr_b16 v[126:127], v246 offset:7168
    ds_read_b64_tr_b16 v[224:225], v246 offset:8192
    ds_read_b64_tr_b16 v[226:227], v246 offset:9216
    v_mfma_f32_32x32x16_bf16 v[64:79], v[208:211], v[16:19], v[64:79]
    ds_read_b64_tr_b16 v[228:229], v246 offset:10240
    ds_read_b64_tr_b16 v[230:231], v246 offset:11264
    ds_read_b64_tr_b16 v[232:233], v246 offset:12288
    v_mfma_f32_32x32x16_bf16 v[80:95], v[212:215], v[20:23], v[80:95]
    ds_read_b64_tr_b16 v[234:235], v246 offset:13312
    ds_read_b64_tr_b16 v[236:237], v246 offset:14336
    ds_read_b64_tr_b16 v[238:239], v246 offset:15360
    v_mfma_f32_32x32x16_bf16 v[64:79], v[216:219], v[24:27], v[64:79]
    s_add_u32 s72, s72, 16384
    s_cmp_eq_u32 s72, 163840
    s_cselect_b32 s72, 0, s72
    s_cmp_eq_u32 s72, 32768
    s_cselect_b32 s72, 98304, s72
    v_add_u32 v246, s72, v245
    v_mfma_f32_32x32x16_bf16 v[80:95], v[220:223], v[28:31], v[80:95]
    s_waitcnt lgkmcnt(14)
    v_mfma_f32_32x32x16_bf16 v[64:79], v[112:115], v[32:35], v[64:79]
    s_waitcnt lgkmcnt(0)
    s_barrier
    ds_read_b64_tr_b16 v[192:193], v246 offset:0
    v_mfma_f32_32x32x16_bf16 v[80:95], v[116:119], v[36:39], v[80:95]
    ds_read_b64_tr_b16 v[194:195], v246 offset:1024
    ds_read_b64_tr_b16 v[196:197], v246 offset:2048
    ds_read_b64_tr_b16 v[198:199], v246 offset:3072
    v_mfma_f32_32x32x16_bf16 v[64:79], v[120:123], v[40:43], v[64:79]
    ds_read_b64_tr_b16 v[200:201], v246 offset:4096
    ds_read_b64_tr_b16 v[202:203], v246 offset:5120
    ds_read_b64_tr_b16 v[204:205], v246 offset:6144
    v_mfma_f32_32x32x16_bf16 v[80:95], v[124:127], v[44:47], v[80:95]
    ds_read_b64_tr_b16 v[206:207], v246 offset:7168
    ds_read_b64_tr_b16 v[208:209], v246 offset:8192
    ds_read_b64_tr_b16 v[210:211], v246 offset:9216
    v_mfma_f32_32x32x16_bf16 v[64:79], v[224:227], v[48:51], v[64:79]
    ds_read_b64_tr_b16 v[212:213], v246 offset:10240
    ds_read_b64_tr_b16 v[214:215], v246 offset:11264
    ds_read_b64_tr_b16 v[216:217], v246 offset:12288
    v_mfma_f32_32x32x16_bf16 v[80:95], v[228:231], v[52:55], v[80:95]
    ds_read_b64_tr_b16 v[218:219], v246 offset:13312
    ds_read_b64_tr_b16 v[220:221], v246 offset:14336
    ds_read_b64_tr_b16 v[222:223], v246 offset:15360
    v_mfma_f32_32x32x16_bf16 v[64:79], v[232:235], v[56:59], v[64:79]
    s_add_u32 s72, s72, 16384
    s_cmp_eq_u32 s72, 163840
    s_cselect_b32 s72, 0, s72
    s_cmp_eq_u32 s72, 32768
    s_cselect_b32 s72, 98304, s72
    v_add_u32 v246, s72, v245
    v_mfma_f32_32x32x16_bf16 v[80:95], v[236:239], v[60:63], v[80:95]
    s_sub_u32 s73, s73, 1
    s_cmp_lg_u32 s73, 0
    s_cbranch_scc1 L_oloop0
    s_branch L_odone
L_oh1:
    s_waitcnt lgkmcnt(14)
    v_mfma_f32_32x32x16_bf16 v[64:79], v[192:195], v[0:3], 0
    s_waitcnt lgkmcnt(0)
    s_barrier
    ds_read_b64_tr_b16 v[112:113], v246 offset:0
    v_mfma_f32_32x32x16_bf16 v[64:79], v[196:199], v[4:7], v[64:79]
    ds_read_b64_tr_b16 v[114:115], v246 offset:1024
    ds_read_b64_tr_b16 v[116:117], v246 offset:2048
    ds_read_b64_tr_b16 v[118:119], v246 offset:3072
    v_mfma_f32_32x32x16_bf16 v[64:79], v[200:203], v[8:11], v[64:79]
    ds_read_b64_tr_b16 v[120:121], v246 offset:4096
    ds_read_b64_tr_b16 v[122:123], v246 offset:5120
    ds_read_b64_tr_b16 v[124:125], v246 offset:6144
    v_mfma_f32_32x32x16_bf16 v[64:79], v[204:207], v[12:15], v[64:79]
    ds_read_b64_tr_b16 v[126:127], v246 offset:7168
    ds_read_b64_tr_b16 v[224:225], v246 offset:8192
    ds_read_b64_tr_b16 v[226:227], v246 offset:9216
    v_mfma_f32_32x32x16_bf16 v[64:79], v[208:211], v[16:19], v[64:79]
    ds_read_b64_tr_b16 v[228:229], v246 offset:10240
    ds_read_b64_tr_b16 v[230:231], v246 offset:11264
    ds_read_b64_tr_b16 v[232:233], v246 offset:12288
    v_mfma_f32_32x32x16_bf16 v[64:79], v[212:215], v[20:23], v[64:79]
    ds_read_b64_tr_b16 v[234:235], v246 offset:13312
    ds_read_b64_tr_b16 v[236:237], v246 offset:14336
    ds_read_b64_tr_b16 v[238:239], v246 offset:15360
    v_mfma_f32_32x32x16_bf16 v[64:79], v[216:219], v[24:27], v[64:79]
    s_add_u32 s72, s72, 16384
    s_cmp_eq_u32 s72, 163840
    s_cselect_b32 s72, 0, s72
    s_cmp_eq_u32 s72, 32768
    s_cselect_b32 s72, 98304, s72
    v_add_u32 v246, s72, v245
    v_mfma_f32_32x32x16_bf16 v[64:79], v[220:223], v[28:31], v[64:79]
    s_waitcnt lgkmcnt(14)
    v_mfma_f32_32x32x16_bf16 v[64:79], v[112:115], v[32:35], v[64:79]
    s_waitcnt lgkmcnt(0)
    s_barrier
    ds_read_b64_tr_b16 v[192:193], v246 offset:0
    v_mfma_f32_32x32x16_bf16 v[80:95], v[116:119], v[36:39], 0
    ds_read_b64_tr_b16 v[194:195], v246 offset:1024
    ds_read_b64_tr_b16 v[196:197], v246 offset:2048
    ds_read_b64_tr_b16 v[198:199], v246 offset:3072
    v_mfma_f32_32x32x16_bf16 v[64:79], v[120:123], v[40:43], v[64:79]
    ds_read_b64_tr_b16 v[200:201], v246 offset:4096
    ds_read_b64_tr_b16 v[202:203], v246 offset:5120
    ds_read_b64_tr_b16 v[204:205], v246 offset:6144
    v_mfma_f32_32x32x16_bf16 v[80:95], v[124:127], v[44:47], v[80:95]
    ds_read_b64_tr_b16 v[206:207], v246 offset:7168
    ds_read_b64_tr_b16 v[208:209], v246 offset:8192
    ds_read_b64_tr_b16 v[210:211], v246 offset:9216
    v_mfma_f32_32x32x16_bf16 v[64:79], v[224:227], v[48:51], v[64:79]
    ds_read_b64_tr_b16 v[212:213], v246 offset:10240
    ds_read_b64_tr_b16 v[214:215], v246 offset:11264
    ds_read_b64_tr_b16 v[216:217], v246 offset:12288
    v_mfma_f32_32x32x16_bf16 v[80:95], v[228:231], v[52:55], v[80:95]
    ds_read_b64_tr_b16 v[218:219], v246 offset:13312
    ds_read_b64_tr_b16 v[220:221], v246 offset:14336
    ds_read_b64_tr_b16 v[222:223], v246 offset:15360
    v_mfma_f32_32x32x16_bf16 v[64:79], v[232:235], v[56:59], v[64:79]
    s_add_u32 s72, s72, 16384
    s_cmp_eq_u32 s72, 163840
    s_cselect_b32 s72, 0, s72
    s_cmp_eq_u32 s72, 32768
    s_cselect_b32 s72, 98304, s72
    v_add_u32 v246, s72, v245
    v_mfma_f32_32x32x16_bf16 v[80:95], v[236:239], v[60:63], v[80:95]
    s_waitcnt lgkmcnt(14)
    v_mfma_f32_32x32x16_bf16 v[64:79], v[192:195], v[128:131], v[64:79]
    s_waitcnt lgkmcnt(0)
    s_barrier
    ds_read_b64_tr_b16 v[112:113], v246 offset:0
    v_mfma_f32_32x32x16_bf16 v[80:95], v[196:199], v[132:135], v[80:95]
    ds_read_b64_tr_b16 v[114:115], v246 offset:1024
    ds_read_b64_tr_b16 v[116:117], v246 offset:2048
    ds_read_b64_tr_b16 v[118:119], v246 offset:3072
    v_mfma_f32_32x32x16_bf16 v[64:79], v[200:203], v[136:139], v[64:79]
    ds_read_b64_tr_b16 v[120:121], v246 offset:4096
    ds_read_b64_tr_b16 v[122:123], v246 offset:5120
    ds_read_b64_tr_b16 v[124:125], v246 offset:6144
    v_mfma_f32_32x32x16_bf16 v[80:95], v[204:207], v[140:143], v[80:95]
    ds_read_b64_tr_b16 v[126:127], v246 offset:7168
    ds_read_b64_tr_b16 v[224:225], v246 offset:8192
    ds_read_b64_tr_b16 v[226:227], v246 offset:9216
    v_mfma_f32_32x32x16_bf16 v[64:79], v[208:211], v[144:147], v[64:79]
    ds_read_b64_tr_b16 v[228:229], v246 offset:10240
    ds_read_b64_tr_b16 v[230:231], v246 offset:11264
    ds_read_b64_tr_b16 v[232:233], v246 offset:12288
    v_mfma_f32_32x32x16_bf16 v[80:95], v[212:215], v[148:151], v[80:95]
    ds_read_b64_tr_b16 v[234:235], v246 offset:13312
    ds_read_b64_tr_b16 v[236:237], v246 offset:14336
    ds_read_b64_tr_b16 v[238:239], v246 offset:15360
    v_mfma_f32_32x32x16_bf16 v[64:79], v[216:219], v[152:155], v[64:79]
    s_add_u32 s72, s72, 16384
    s_cmp_eq_u32 s72, 163840
    s_cselect_b32 s72, 0, s72
    s_cmp_eq_u32 s72, 32768
    s_cselect_b32 s72, 98304, s72
    v_add_u32 v246, s72, v245
    v_mfma_f32_32x32x16_bf16 v[80:95], v[220:223], v[156:159], v[80:95]
    s_waitcnt lgkmcnt(14)
    v_mfma_f32_32x32x16_bf16 v[64:79], v[112:115], v[160:163], v[64:79]
    s_waitcnt lgkmcnt(0)
    s_barrier
    ds_read_b64_tr_b16 v[192:193], v246 offset:0
    v_mfma_f32_32x32x16_bf16 v[80:95], v[116:119], v[164:167], v[80:95]
    ds_read_b64_tr_b16 v[194:195], v246 offset:1024
    ds_read_b64_tr_b16 v[196:197], v246 offset:2048
    ds_read_b64_tr_b16 v[198:199], v246 offset:3072
    v_mfma_f32_32x32x16_bf16 v[64:79], v[120:123], v[168:171], v[64:79]
    ds_read_b64_tr_b16 v[200:201], v246 offset:4096
    ds_read_b64_tr_b16 v[202:203], v246 offset:5120
    ds_read_b64_tr_b16 v[204:205], v246 offset:6144
    v_mfma_f32_32x32x16_bf16 v[80:95], v[124:127], v[172:175], v[80:95]
    ds_read_b64_tr_b16 v[206:207], v246 offset:7168
    ds_read_b64_tr_b16 v[208:209], v246 offset:8192
    ds_read_b64_tr_b16 v[210:211], v246 offset:9216
    v_mfma_f32_32x32x16_bf16 v[64:79], v[224:227], v[176:179], v[64:79]
    ds_read_b64_tr_b16 v[212:213], v246 offset:10240
    ds_read_b64_tr_b16 v[214:215], v246 offset:11264
    ds_read_b64_tr_b16 v[216:217], v246 offset:12288
    v_mfma_f32_32x32x16_bf16 v[80:95], v[228:231], v[180:183], v[80:95]
    ds_read_b64_tr_b16 v[218:219], v246 offset:13312
    ds_read_b64_tr_b16 v[220:221], v246 offset:14336
    ds_read_b64_tr_b16 v[222:223], v246 offset:15360
    v_mfma_f32_32x32x16_bf16 v[64:79], v[232:235], v[184:187], v[64:79]
    s_add_u32 s72, s72, 16384
    s_cmp_eq_u32 s72, 163840
    s_cselect_b32 s72, 0, s72
    s_cmp_eq_u32 s72, 32768
    s_cselect_b32 s72, 98304, s72
    v_add_u32 v246, s72, v245
    v_mfma_f32_32x32x16_bf16 v[80:95], v[236:239], v[188:191], v[80:95]
L_oloop1:
    s_waitcnt lgkmcnt(14)
    v_mfma_f32_32x32x16_bf16 v[96:111], v[192:195], v[0:3], 0
    s_waitcnt lgkmcnt(0)
    s_barrier
    ds_read_b64_tr_b16 v[112:113], v246 offset:0
    v_mfma_f32_32x32x16_bf16 v[96:111], v[196:199], v[4:7], v[96:111]
    ds_read_b64_tr_b16 v[114:115], v246 offset:1024
    ds_read_b64_tr_b16 v[116:117], v246 offset:2048
    ds_read_b64_tr_b16 v[118:119], v246 offset:3072
    v_add_f32 v64, v64, v80
    v_add_f32 v65, v65, v81
    v_mfma_f32_32x32x16_bf16 v[96:111], v[200:203], v[8:11], v[96:111]
    ds_read_b64_tr_b16 v[120:121], v246 offset:4096
    ds_read_b64_tr_b16 v[122:123], v246 offset:5120
    ds_read_b64_tr_b16 v[124:125], v246 offset:6144
    v_add_f32 v66, v66, v82
    v_add_f32 v67, v67, v83
    v_mfma_f32_32x32x16_bf16 v[96:111], v[204:207], v[12:15], v[96:111]
    ds_read_b64_tr_b16 v[126:127], v246 offset:7168
    ds_read_b64_tr_b16 v[224:225], v246 offset:8192
    ds_read_b64_tr_b16 v[226:227], v246 offset:9216
    v_add_f32 v68, v68, v84
    v_add_f32 v69, v69, v85
    v_mfma_f32_32x32x16_bf16 v[96:111], v[208:211], v[16:19], v[96:111]
    ds_read_b64_tr_b16 v[228:229], v246 offset:10240
    ds_read_b64_tr_b16 v[230:231], v246 offset:11264
    ds_read_b64_tr_b16 v[232:233], v246 offset:12288
    v_add_f32 v70, v70, v86
    v_add_f32 v71, v71, v87
    v_mfma_f32_32x32x16_bf16 v[96:111], v[212:215], v[20:23], v[96:111]
    ds_read_b64_tr_b16 v[234:235], v246 offset:13312
    ds_read_b64_tr_b16 v[236:237], v246 offset:14336
    ds_read_b64_tr_b16 v[238:239], v246 offset:15360
    v_add_f32 v72, v72, v88
    v_add_f32 v73, v73, v89
    v_mfma_f32_32x32x16_bf16 v[96:111], v[216:219], v[24:27], v[96:111]
    s_add_u32 s72, s72, 16384
    s_cmp_eq_u32 s72, 163840
    s_cselect_b32 s72, 0, s72
    s_cmp_eq_u32 s72, 32768
    s_cselect_b32 s72, 98304, s72
    v_add_u32 v246, s72, v245
    v_add_f32 v74, v74, v90
    v_add_f32 v75, v75, v91
    v_mfma_f32_32x32x16_bf16 v[96:111], v[220:223], v[28:31], v[96:111]
    v_add_f32 v76, v76, v92
    v_add_f32 v77, v77, v93
    s_waitcnt lgkmcnt(14)
    v_mfma_f32_32x32x16_bf16 v[96:111], v[112:115], v[32:35], v[96:111]
    s_waitcnt lgkmcnt(0)
    s_barrier
    ds_read_b64_tr_b16 v[192:193], v246 offset:0
    v_add_f32 v78, v78, v94
    v_add_f32 v79, v79, v95
    v_mfma_f32_32x32x16_bf16 v[80:95], v[116:119], v[36:39], 0
    ds_read_b64_tr_b16 v[194:195], v246 offset:1024
    ds_read_b64_tr_b16 v[196:197], v246 offset:2048
    ds_read_b64_tr_b16 v[198:199], v246 offset:3072
    v_cvt_pk_bf16_f32 v64, v64, v65
    v_cvt_pk_bf16_f32 v65, v66, v67
    v_mfma_f32_32x32x16_bf16 v[96:111], v[120:123], v[40:43], v[96:111]
    ds_read_b64_tr_b16 v[200:201], v246 offset:4096
    ds_read_b64_tr_b16 v[202:203], v246 offset:5120
    ds_read_b64_tr_b16 v[204:205], v246 offset:6144
    v_cvt_pk_bf16_f32 v66, v68, v69
    v_cvt_pk_bf16_f32 v67, v70, v71
    v_mfma_f32_32x32x16_bf16 v[80:95], v[124:127], v[44:47], v[80:95]
    ds_read_b64_tr_b16 v[206:207], v246 offset:7168
    ds_read_b64_tr_b16 v[208:209], v246 offset:8192
    ds_read_b64_tr_b16 v[210:211], v246 offset:9216
    v_cvt_pk_bf16_f32 v68, v72, v73
    v_cvt_pk_bf16_f32 v69, v74, v75
    v_mfma_f32_32x32x16_bf16 v[96:111], v[224:227], v[48:51], v[96:111]
    ds_read_b64_tr_b16 v[212:213], v246 offset:10240
    ds_read_b64_tr_b16 v[214:215], v246 offset:11264
    ds_read_b64_tr_b16 v[216:217], v246 offset:12288
    v_cvt_pk_bf16_f32 v70, v76, v77
    v_cvt_pk_bf16_f32 v71, v78, v79
    v_mfma_f32_32x32x16_bf16 v[80:95], v[228:231], v[52:55], v[80:95]
    ds_read_b64_tr_b16 v[218:219], v246 offset:13312
    ds_read_b64_tr_b16 v[220:221], v246 offset:14336
    ds_read_b64_tr_b16 v[222:223], v246 offset:15360
    buffer_store_dwordx4 v[64:67], v249, s[52:55], s10 offen sc1
    buffer_store_dwordx4 v[68:71], v249, s[52:55], s10 offen offset:1024 sc1
    v_mfma_f32_32x32x16_bf16 v[96:111], v[232:235], v[56:59], v[96:111]
    s_add_u32 s72, s72, 16384
    s_cmp_eq_u32 s72, 163840
    s_cselect_b32 s72, 0, s72
    s_cmp_eq_u32 s72, 32768
    s_cselect_b32 s72, 98304, s72
    v_add_u32 v246, s72, v245
    s_add_u32 s10, s10, 4096
    v_mfma_f32_32x32x16_bf16 v[80:95], v[236:239], v[60:63], v[80:95]
    s_waitcnt lgkmcnt(14)
    v_mfma_f32_32x32x16_bf16 v[96:111], v[192:195], v[128:131], v[96:111]
    s_waitcnt lgkmcnt(0)
    s_barrier
    ds_read_b64_tr_b16 v[112:113], v246 offset:0
    v_mfma_f32_32x32x16_bf16 v[80:95], v[196:199], v[132:135], v[80:95]
    ds_read_b64_tr_b16 v[114:115], v246 offset:1024
    ds_read_b64_tr_b16 v[116:117], v246 offset:2048
    ds_read_b64_tr_b16 v[118:119], v246 offset:3072
    v_mfma_f32_32x32x16_bf16 v[96:111], v[200:203], v[136:139], v[96:111]
    ds_read_b64_tr_b16 v[120:121], v246 offset:4096
    ds_read_b64_tr_b16 v[122:123], v246 offset:5120
    ds_read_b64_tr_b16 v[124:125], v246 offset:6144
    v_mfma_f32_32x32x16_bf16 v[80:95], v[204:207], v[140:143], v[80:95]
    ds_read_b64_tr_b16 v[126:127], v246 offset:7168
    ds_read_b64_tr_b16 v[224:225], v246 offset:8192
    ds_read_b64_tr_b16 v[226:227], v246 offset:9216
    v_mfma_f32_32x32x16_bf16 v[96:111], v[208:211], v[144:147], v[96:111]
    ds_read_b64_tr_b16 v[228:229], v246 offset:10240
    ds_read_b64_tr_b16 v[230:231], v246 offset:11264
    ds_read_b64_tr_b16 v[232:233], v246 offset:12288
    v_mfma_f32_32x32x16_bf16 v[80:95], v[212:215], v[148:151], v[80:95]
    ds_read_b64_tr_b16 v[234:235], v246 offset:13312
    ds_read_b64_tr_b16 v[236:237], v246 offset:14336
    ds_read_b64_tr_b16 v[238:239], v246 offset:15360
    v_mfma_f32_32x32x16_bf16 v[96:111], v[216:219], v[152:155], v[96:111]
    s_add_u32 s72, s72, 16384
    s_cmp_eq_u32 s72, 163840
    s_cselect_b32 s72, 0, s72
    s_cmp_eq_u32 s72, 32768
    s_cselect_b32 s72, 98304, s72
    v_add_u32 v246, s72, v245
    v_mfma_f32_32x32x16_bf16 v[80:95], v[220:223], v[156:159], v[80:95]
    s_waitcnt lgkmcnt(14)
    v_mfma_f32_32x32x16_bf16 v[96:111], v[112:115], v[160:163], v[96:111]
    s_waitcnt lgkmcnt(0)
    s_barrier
    ds_read_b64_tr_b16 v[192:193], v246 offset:0
    v_mfma_f32_32x32x16_bf16 v[80:95], v[116:119], v[164:167], v[80:95]
    ds_read_b64_tr_b16 v[194:195], v246 offset:1024
    ds_read_b64_tr_b16 v[196:197], v246 offset:2048
    ds_read_b64_tr_b16 v[198:199], v246 offset:3072
    v_mfma_f32_32x32x16_bf16 v[96:111], v[120:123], v[168:171], v[96:111]
    ds_read_b64_tr_b16 v[200:201], v246 offset:4096
    ds_read_b64_tr_b16 v[202:203], v246 offset:5120
    ds_read_b64_tr_b16 v[204:205], v246 offset:6144
    v_mfma_f32_32x32x16_bf16 v[80:95], v[124:127], v[172:175], v[80:95]
    ds_read_b64_tr_b16 v[206:207], v246 offset:7168
    ds_read_b64_tr_b16 v[208:209], v246 offset:8192
    ds_read_b64_tr_b16 v[210:211], v246 offset:9216
    v_mfma_f32_32x32x16_bf16 v[96:111], v[224:227], v[176:179], v[96:111]
    ds_read_b64_tr_b16 v[212:213], v246 offset:10240
    ds_read_b64_tr_b16 v[214:215], v246 offset:11264
    ds_read_b64_tr_b16 v[216:217], v246 offset:12288
    v_mfma_f32_32x32x16_bf16 v[80:95], v[228:231], v[180:183], v[80:95]
    ds_read_b64_tr_b16 v[218:219], v246 offset:13312
    ds_read_b64_tr_b16 v[220:221], v246 offset:14336
    ds_read_b64_tr_b16 v[222:223], v246 offset:15360
    v_mfma_f32_32x32x16_bf16 v[96:111], v[232:235], v[184:187], v[96:111]
    s_add_u32 s72, s72, 16384
    s_cmp_eq_u32 s72, 163840
    s_cselect_b32 s72, 0, s72
    s_cmp_eq_u32 s72, 32768
    s_cselect_b32 s72, 98304, s72
    v_add_u32 v246, s72, v245
    v_mfma_f32_32x32x16_bf16 v[80:95], v[236:239], v[188:191], v[80:95]
    s_waitcnt lgkmcnt(14)
    v_mfma_f32_32x32x16_bf16 v[64:79], v[192:195], v[0:3], 0
    s_waitcnt lgkmcnt(0)
    s_barrier
    ds_read_b64_tr_b16 v[112:113], v246 offset:0
    v_mfma_f32_32x32x16_bf16 v[64:79], v[196:199], v[4:7], v[64:79]
    ds_read_b64_tr_b16 v[114:115], v246 offset:1024
    ds_read_b64_tr_b16 v[116:117], v246 offset:2048
    ds_read_b64_tr_b16 v[118:119], v246 offset:3072
    v_add_f32 v96, v96, v80
    v_add_f32 v97, v97, v81
    v_mfma_f32_32x32x16_bf16 v[64:79], v[200:203], v[8:11], v[64:79]
    ds_read_b64_tr_b16 v[120:121], v246 offset:4096
    ds_read_b64_tr_b16 v[122:123], v246 offset:5120
    ds_read_b64_tr_b16 v[124:125], v246 offset:6144
    v_add_f32 v98, v98, v82
    v_add_f32 v99, v99, v83
    v_mfma_f32_32x32x16_bf16 v[64:79], v[204:207], v[12:15], v[64:79]
    ds_read_b64_tr_b16 v[126:127], v246 offset:7168
    ds_read_b64_tr_b16 v[224:225], v246 offset:8192
    ds_read_b64_tr_b16 v[226:227], v246 offset:9216
    v_add_f32 v100, v100, v84
    v_add_f32 v101, v101, v85
    v_mfma_f32_32x32x16_bf16 v[64:79], v[208:211], v[16:19], v[64:79]
    ds_read_b64_tr_b16 v[228:229], v246 offset:10240
    ds_read_b64_tr_b16 v[230:231], v246 offset:11264
    ds_read_b64_tr_b16 v[232:233], v246 offset:12288
    v_add_f32 v102, v102, v86
    v_add_f32 v103, v103, v87
    v_mfma_f32_32x32x16_bf16 v[64:79], v[212:215], v[20:23], v[64:79]
    ds_read_b64_tr_b16 v[234:235], v246 offset:13312
    ds_read_b64_tr_b16 v[236:237], v246 offset:14336
    ds_read_b64_tr_b16 v[238:239], v246 offset:15360
    v_add_f32 v104, v104, v88
    v_add_f32 v105, v105, v89
    v_mfma_f32_32x32x16_bf16 v[64:79], v[216:219], v[24:27], v[64:79]
    s_add_u32 s72, s72, 16384
    s_cmp_eq_u32 s72, 163840
    s_cselect_b32 s72, 0, s72
    s_cmp_eq_u32 s72, 32768
    s_cselect_b32 s72, 98304, s72
    v_add_u32 v246, s72, v245
    v_add_f32 v106, v106, v90
    v_add_f32 v107, v107, v91
    v_mfma_f32_32x32x16_bf16 v[64:79], v[220:223], v[28:31], v[64:79]
    v_add_f32 v108, v108, v92
    v_add_f32 v109, v109, v93
    s_waitcnt lgkmcnt(14)
    v_mfma_f32_32x32x16_bf16 v[64:79], v[112:115], v[32:35], v[64:79]
    s_waitcnt lgkmcnt(0)
    s_barrier
    ds_read_b64_tr_b16 v[192:193], v246 offset:0
    v_add_f32 v110, v110, v94
    v_add_f32 v111, v111, v95
    v_mfma_f32_32x32x16_bf16 v[80:95], v[116:119], v[36:39], 0
    ds_read_b64_tr_b16 v[194:195], v246 offset:1024
    ds_read_b64_tr_b16 v[196:197], v246 offset:2048
    ds_read_b64_tr_b16 v[198:199], v246 offset:3072
    v_cvt_pk_bf16_f32 v96, v96, v97
    v_cvt_pk_bf16_f32 v97, v98, v99
    v_mfma_f32_32x32x16_bf16 v[64:79], v[120:123], v[40:43], v[64:79]
    ds_read_b64_tr_b16 v[200:201], v246 offset:4096
    ds_read_b64_tr_b16 v[202:203], v246 offset:5120
    ds_read_b64_tr_b16 v[204:205], v246 offset:6144
    v_cvt_pk_bf16_f32 v98, v100, v101
    v_cvt_pk_bf16_f32 v99, v102, v103
    v_mfma_f32_32x32x16_bf16 v[80:95], v[124:127], v[44:47], v[80:95]
    ds_read_b64_tr_b16 v[206:207], v246 offset:7168
    ds_read_b64_tr_b16 v[208:209], v246 offset:8192
    ds_read_b64_tr_b16 v[210:211], v246 offset:9216
    v_cvt_pk_bf16_f32 v100, v104, v105
    v_cvt_pk_bf16_f32 v101, v106, v107
    v_mfma_f32_32x32x16_bf16 v[64:79], v[224:227], v[48:51], v[64:79]
    ds_read_b64_tr_b16 v[212:213], v246 offset:10240
    ds_read_b64_tr_b16 v[214:215], v246 offset:11264
    ds_read_b64_tr_b16 v[216:217], v246 offset:12288
    v_cvt_pk_bf16_f32 v102, v108, v109
    v_cvt_pk_bf16_f32 v103, v110, v111
    v_mfma_f32_32x32x16_bf16 v[80:95], v[228:231], v[52:55], v[80:95]
    ds_read_b64_tr_b16 v[218:219], v246 offset:13312
    ds_read_b64_tr_b16 v[220:221], v246 offset:14336
    ds_read_b64_tr_b16 v[222:223], v246 offset:15360
    buffer_store_dwordx4 v[96:99], v249, s[52:55], s10 offen sc1
    buffer_store_dwordx4 v[100:103], v249, s[52:55], s10 offen offset:1024 sc1
    v_mfma_f32_32x32x16_bf16 v[64:79], v[232:235], v[56:59], v[64:79]
    s_add_u32 s72, s72, 16384
    s_cmp_eq_u32 s72, 163840
    s_cselect_b32 s72, 0, s72
    s_cmp_eq_u32 s72, 32768
    s_cselect_b32 s72, 98304, s72
    v_add_u32 v246, s72, v245
    s_add_u32 s10, s10, 4096
    v_mfma_f32_32x32x16_bf16 v[80:95], v[236:239], v[60:63], v[80:95]
    s_waitcnt lgkmcnt(14)
    v_mfma_f32_32x32x16_bf16 v[64:79], v[192:195], v[128:131], v[64:79]
    s_waitcnt lgkmcnt(0)
    s_barrier
    ds_read_b64_tr_b16 v[112:113], v246 offset:0
    v_mfma_f32_32x32x16_bf16 v[80:95], v[196:199], v[132:135], v[80:95]
    ds_read_b64_tr_b16 v[114:115], v246 offset:1024
    ds_read_b64_tr_b16 v[116:117], v246 offset:2048
    ds_read_b64_tr_b16 v[118:119], v246 offset:3072
    v_mfma_f32_32x32x16_bf16 v[64:79], v[200:203], v[136:139], v[64:79]
    ds_read_b64_tr_b16 v[120:121], v246 offset:4096
    ds_read_b64_tr_b16 v[122:123], v246 offset:5120
    ds_read_b64_tr_b16 v[124:125], v246 offset:6144
    v_mfma_f32_32x32x16_bf16 v[80:95], v[204:207], v[140:143], v[80:95]
    ds_read_b64_tr_b16 v[126:127], v246 offset:7168
    ds_read_b64_tr_b16 v[224:225], v246 offset:8192
    ds_read_b64_tr_b16 v[226:227], v246 offset:9216
    v_mfma_f32_32x32x16_bf16 v[64:79], v[208:211], v[144:147], v[64:79]
    ds_read_b64_tr_b16 v[228:229], v246 offset:10240
    ds_read_b64_tr_b16 v[230:231], v246 offset:11264
    ds_read_b64_tr_b16 v[232:233], v246 offset:12288
    v_mfma_f32_32x32x16_bf16 v[80:95], v[212:215], v[148:151], v[80:95]
    ds_read_b64_tr_b16 v[234:235], v246 offset:13312
    ds_read_b64_tr_b16 v[236:237], v246 offset:14336
    ds_read_b64_tr_b16 v[238:239], v246 offset:15360
    v_mfma_f32_32x32x16_bf16 v[64:79], v[216:219], v[152:155], v[64:79]
    s_add_u32 s72, s72, 16384
    s_cmp_eq_u32 s72, 163840
    s_cselect_b32 s72, 0, s72
    s_cmp_eq_u32 s72, 32768
    s_cselect_b32 s72, 98304, s72
    v_add_u32 v246, s72, v245
    v_mfma_f32_32x32x16_bf16 v[80:95], v[220:223], v[156:159], v[80:95]
    s_waitcnt lgkmcnt(14)
    v_mfma_f32_32x32x16_bf16 v[64:79], v[112:115], v[160:163], v[64:79]
    s_waitcnt lgkmcnt(0)
    s_barrier
    ds_read_b64_tr_b16 v[192:193], v246 offset:0
    v_mfma_f32_32x32x16_bf16 v[80:95], v[116:119], v[164:167], v[80:95]
    ds_read_b64_tr_b16 v[194:195], v246 offset:1024
    ds_read_b64_tr_b16 v[196:197], v246 offset:2048
    ds_read_b64_tr_b16 v[198:199], v246 offset:3072
    v_mfma_f32_32x32x16_bf16 v[64:79], v[120:123], v[168:171], v[64:79]
    ds_read_b64_tr_b16 v[200:201], v246 offset:4096
    ds_read_b64_tr_b16 v[202:203], v246 offset:5120
    ds_read_b64_tr_b16 v[204:205], v246 offset:6144
    v_mfma_f32_32x32x16_bf16 v[80:95], v[124:127], v[172:175], v[80:95]
    ds_read_b64_tr_b16 v[206:207], v246 offset:7168
    ds_read_b64_tr_b16 v[208:209], v246 offset:8192
    ds_read_b64_tr_b16 v[210:211], v246 offset:9216
    v_mfma_f32_32x32x16_bf16 v[64:79], v[224:227], v[176:179], v[64:79]
    ds_read_b64_tr_b16 v[212:213], v246 offset:10240
    ds_read_b64_tr_b16 v[214:215], v246 offset:11264
    ds_read_b64_tr_b16 v[216:217], v246 offset:12288
    v_mfma_f32_32x32x16_bf16 v[80:95], v[228:231], v[180:183], v[80:95]
    ds_read_b64_tr_b16 v[218:219], v246 offset:13312
    ds_read_b64_tr_b16 v[220:221], v246 offset:14336
    ds_read_b64_tr_b16 v[222:223], v246 offset:15360
    v_mfma_f32_32x32x16_bf16 v[64:79], v[232:235], v[184:187], v[64:79]
    s_add_u32 s72, s72, 16384
    s_cmp_eq_u32 s72, 163840
    s_cselect_b32 s72, 0, s72
    s_cmp_eq_u32 s72, 32768
    s_cselect_b32 s72, 98304, s72
    v_add_u32 v246, s72, v245
    v_mfma_f32_32x32x16_bf16 v[80:95], v[236:239], v[188:191], v[80:95]
    s_sub_u32 s73, s73, 1
    s_cmp_lg_u32 s73, 0
    s_cbranch_scc1 L_oloop1
L_odone:
    s_nop 7
    s_nop 3
    v_add_f32 v64, v64, v80
    v_add_f32 v65, v65, v81
    v_add_f32 v66, v66, v82
    v_add_f32 v67, v67, v83
    v_add_f32 v68, v68, v84
    v_add_f32 v69, v69, v85
    v_add_f32 v70, v70, v86
    v_add_f32 v71, v71, v87
    v_add_f32 v72, v72, v88
    v_add_f32 v73, v73, v89
    v_add_f32 v74, v74, v90
    v_add_f32 v75, v75, v91
    v_add_f32 v76, v76, v92
    v_add_f32 v77, v77, v93
    v_add_f32 v78, v78, v94
    v_add_f32 v79, v79, v95
    v_cvt_pk_bf16_f32 v64, v64, v65
    v_cvt_pk_bf16_f32 v65, v66, v67
    v_cvt_pk_bf16_f32 v66, v68, v69
    v_cvt_pk_bf16_f32 v67, v70, v71
    v_cvt_pk_bf16_f32 v68, v72, v73
    v_cvt_pk_bf16_f32 v69, v74, v75
    v_cvt_pk_bf16_f32 v70, v76, v77
    v_cvt_pk_bf16_f32 v71, v78, v79
    buffer_store_dwordx4 v[64:67], v249, s[52:55], s10 offen sc1
    buffer_store_dwordx4 v[68:71], v249, s[52:55], s10 offen offset:1024 sc1
    s_add_u32 s10, s10, 4096
    s_waitcnt vmcnt(0)
L_tail:
    s_barrier
    v_mbcnt_lo_u32_b32 v0, -1, 0
    v_mbcnt_hi_u32_b32 v0, -1, v0
    s_cmp_lg_u32 s3, 7
    s_cbranch_scc1 L_nopoll
    s_mov_b64 exec, 0xff
    buffer_store_dword v2, v4, s[16:19], 0 offen sc1
    s_mov_b32 s73, 0x40000
L_poll:
    buffer_load_dword v3, v1, s[16:19], 0 offen sc1
    s_waitcnt vmcnt(0)
    v_cmp_eq_u32 vcc, 1, v3
    s_cmp_eq_u32 vcc_lo, 0xff
    s_cbranch_scc1 L_polled
    s_sleep 1
    s_sub_u32 s73, s73, 1
    s_cmp_lg_u32 s73, 0
    s_cbranch_scc1 L_poll
L_polled:
    s_mov_b64 exec, -1
    s_barrier
    s_endpgm
L_nopoll:
    s_mov_b32 s12, s3
    s_lshl_b32 s68, s64, 4
    s_add_u32 s68, s68, s65
    s_mul_i32 s68, s68, 458752
    s_add_u32 s52, s28, s68
    s_addc_u32 s53, s29, 0
    s_and_b32 s53, s53, 0xffff
    s_mov_b32 s54, 458752
    s_mov_b32 s55, 0x20000
    s_mov_b32 s68, 0
    s_add_u32 s60, s24, s68
    s_addc_u32 s61, s25, 0
    s_and_b32 s61, s61, 0xffff
    s_mov_b32 s62, 1835008
    s_mov_b32 s63, 0x20000
    v_lshrrev_b32 v2, 4, v0
    v_bfe_u32 v3, v0, 3, 1
    v_and_b32 v4, 7, v0
    v_lshlrev_b32 v1, 10, v2
    v_lshl_add_u32 v1, v3, 9, v1
    v_lshl_add_u32 v1, v4, 4, v1
    s_lshr_b32 s69, s66, 2
    s_mul_i32 s69, s69, 28672
    s_and_b32 s70, s66, 3
    s_lshl_b32 s70, s70, 7
    s_lshl_b32 s68, s12, 12
    s_add_u32 s68, s68, s69
    s_add_u32 s68, s68, s70
    v_mul_u32_u24 v4, 1792, v4
    v_lshl_add_u32 v4, v3, 5, v4
    v_lshrrev_b32 v3, 1, v2
    v_lshl_add_u32 v4, v3, 6, v4
    v_and_b32 v3, 1, v2
    v_lshl_add_u32 v2, v3, 4, v4
    s_lshl_b32 s72, s65, 3
    s_add_u32 s72, s72, s66
    s_mul_i32 s72, s72, 14336
    s_mul_i32 s69, s64, 896
    s_add_u32 s72, s72, s69
    s_lshl_b32 s69, s12, 7
    s_add_u32 s72, s72, s69
    s_barrier
    buffer_load_dwordx4 v[8:11], v1, s[52:55], s68 offen sc1
    s_add_u32 s68, s68, 57344
    buffer_load_dwordx4 v[12:15], v1, s[52:55], s68 offen sc1
    s_add_u32 s68, s68, 57344
    buffer_load_dwordx4 v[16:19], v1, s[52:55], s68 offen sc1
    s_add_u32 s68, s68, 57344
    buffer_load_dwordx4 v[20:23], v1, s[52:55], s68 offen sc1
    s_add_u32 s68, s68, 57344
    buffer_load_dwordx4 v[24:27], v1, s[52:55], s68 offen sc1
    s_add_u32 s68, s68, 57344
    buffer_load_dwordx4 v[28:31], v1, s[52:55], s68 offen sc1
    s_add_u32 s68, s68, 57344
    buffer_load_dwordx4 v[32:35], v1, s[52:55], s68 offen sc1
    s_add_u32 s68, s68, 57344
    buffer_load_dwordx4 v[36:39], v1, s[52:55], s68 offen sc1
    s_waitcnt vmcnt(7)
    v_lshlrev_b32 v40, 16, v8
    v_and_b32 v41, 0xffff0000, v8
    v_lshlrev_b32 v42, 16, v9
    v_and_b32 v43, 0xffff0000, v9
    v_lshlrev_b32 v44, 16, v10
    v_and_b32 v45, 0xffff0000, v10
    v_lshlrev_b32 v46, 16, v11
    v_and_b32 v47, 0xffff0000, v11
    s_waitcnt vmcnt(6)
    v_lshlrev_b32 v4, 16, v12
    v_and_b32 v5, 0xffff0000, v12
    v_add_f32 v40, v40, v4
    v_add_f32 v41, v41, v5
    v_lshlrev_b32 v4, 16, v13
    v_and_b32 v5, 0xffff0000, v13
    v_add_f32 v42, v42, v4
    v_add_f32 v43, v43, v5
    v_lshlrev_b32 v4, 16, v14
    v_and_b32 v5, 0xffff0000, v14
    v_add_f32 v44, v44, v4
    v_add_f32 v45, v45, v5
    v_lshlrev_b32 v4, 16, v15
    v_and_b32 v5, 0xffff0000, v15
    v_add_f32 v46, v46, v4
    v_add_f32 v47, v47, v5
    s_waitcnt vmcnt(5)
    v_lshlrev_b32 v4, 16, v16
    v_and_b32 v5, 0xffff0000, v16
    v_add_f32 v40, v40, v4
    v_add_f32 v41, v41, v5
    v_lshlrev_b32 v4, 16, v17
    v_and_b32 v5, 0xffff0000, v17
    v_add_f32 v42, v42, v4
    v_add_f32 v43, v43, v5
    v_lshlrev_b32 v4, 16, v18
    v_and_b32 v5, 0xffff0000, v18
    v_add_f32 v44, v44, v4
    v_add_f32 v45, v45, v5
    v_lshlrev_b32 v4, 16, v19
    v_and_b32 v5, 0xffff0000, v19
    v_add_f32 v46, v46, v4
    v_add_f32 v47, v47, v5
    s_waitcnt vmcnt(4)
    v_lshlrev_b32 v4, 16, v20
    v_and_b32 v5, 0xffff0000, v20
    v_add_f32 v40, v40, v4
    v_add_f32 v41, v41, v5
    v_lshlrev_b32 v4, 16, v21
    v_and_b32 v5, 0xffff0000, v21
    v_add_f32 v42, v42, v4
    v_add_f32 v43, v43, v5
    v_lshlrev_b32 v4, 16, v22
    v_and_b32 v5, 0xffff0000, v22
    v_add_f32 v44, v44, v4
    v_add_f32 v45, v45, v5
    v_lshlrev_b32 v4, 16, v23
    v_and_b32 v5, 0xffff0000, v23
    v_add_f32 v46, v46, v4
    v_add_f32 v47, v47, v5
    s_waitcnt vmcnt(3)
    v_lshlrev_b32 v4, 16, v24
    v_and_b32 v5, 0xffff0000, v24
    v_add_f32 v40, v40, v4
    v_add_f32 v41, v41, v5
    v_lshlrev_b32 v4, 16, v25
    v_and_b32 v5, 0xffff0000, v25
    v_add_f32 v42, v42, v4
    v_add_f32 v43, v43, v5
    v_lshlrev_b32 v4, 16, v26
    v_and_b32 v5, 0xffff0000, v26
    v_add_f32 v44, v44, v4
    v_add_f32 v45, v45, v5
    v_lshlrev_b32 v4, 16, v27
    v_and_b32 v5, 0xffff0000, v27
    v_add_f32 v46, v46, v4
    v_add_f32 v47, v47, v5
    s_waitcnt vmcnt(2)
    v_lshlrev_b32 v4, 16, v28
    v_and_b32 v5, 0xffff0000, v28
    v_add_f32 v40, v40, v4
    v_add_f32 v41, v41, v5
    v_lshlrev_b32 v4, 16, v29
    v_and_b32 v5, 0xffff0000, v29
    v_add_f32 v42, v42, v4
    v_add_f32 v43, v43, v5
    v_lshlrev_b32 v4, 16, v30
    v_and_b32 v5, 0xffff0000, v30
    v_add_f32 v44, v44, v4
    v_add_f32 v45, v45, v5
    v_lshlrev_b32 v4, 16, v31
    v_and_b32 v5, 0xffff0000, v31
    v_add_f32 v46, v46, v4
    v_add_f32 v47, v47, v5
    s_waitcnt vmcnt(1)
    v_lshlrev_b32 v4, 16, v32
    v_and_b32 v5, 0xffff0000, v32
    v_add_f32 v40, v40, v4
    v_add_f32 v41, v41, v5
    v_lshlrev_b32 v4, 16, v33
    v_and_b32 v5, 0xffff0000, v33
    v_add_f32 v42, v42, v4
    v_add_f32 v43, v43, v5
    v_lshlrev_b32 v4, 16, v34
    v_and_b32 v5, 0xffff0000, v34
    v_add_f32 v44, v44, v4
    v_add_f32 v45, v45, v5
    v_lshlrev_b32 v4, 16, v35
    v_and_b32 v5, 0xffff0000, v35
    v_add_f32 v46, v46, v4
    v_add_f32 v47, v47, v5
    s_waitcnt vmcnt(0)
    v_lshlrev_b32 v4, 16, v36
    v_and_b32 v5, 0xffff0000, v36
    v_add_f32 v40, v40, v4
    v_add_f32 v41, v41, v5
    v_lshlrev_b32 v4, 16, v37
    v_and_b32 v5, 0xffff0000, v37
    v_add_f32 v42, v42, v4
    v_add_f32 v43, v43, v5
    v_lshlrev_b32 v4, 16, v38
    v_and_b32 v5, 0xffff0000, v38
    v_add_f32 v44, v44, v4
    v_add_f32 v45, v45, v5
    v_lshlrev_b32 v4, 16, v39
    v_and_b32 v5, 0xffff0000, v39
    v_add_f32 v46, v46, v4
    v_add_f32 v47, v47, v5
    v_cvt_pk_bf16_f32 v48, v40, v41
    v_cvt_pk_bf16_f32 v49, v42, v43
    v_cvt_pk_bf16_f32 v50, v44, v45
    v_cvt_pk_bf16_f32 v51, v46, v47
    buffer_store_dwordx4 v[48:51], v2, s[60:63], s72 offen sc1
    s_endpgm
L_end:
    s_endpgm
.section .rodata,"a"
.p2align 6
.amdhsa_kernel concat_heads__mha_block_cached__mha_block_cached__near_ridge_kernel
  .amdhsa_next_free_vgpr 256
  .amdhsa_next_free_sgpr 102
  .amdhsa_accum_offset 256
  .amdhsa_group_segment_fixed_size 0
  .amdhsa_kernarg_size 104
  .amdhsa_user_sgpr_count 2
  .amdhsa_user_sgpr_kernarg_segment_ptr 1
  .amdhsa_system_sgpr_workgroup_id_x 1
.end_amdhsa_kernel
```
